```python
import torch

def _softmax(x, axis=-1):
    return torch.softmax(x, dim=axis)
def _gelu(x):
    return torch.nn.functional.gelu(x, approximate="tanh")
def _silu(x):
    return torch.nn.functional.silu(x)
def _sigmoid(x):
    return torch.sigmoid(x)
def _layernorm(x, axis=-1, eps=1e-5):
    m = x.mean(dim=axis, keepdim=True)
    v = x.var(dim=axis, keepdim=True, unbiased=False)
    return (x - m) / torch.sqrt(v + eps)
def _scatter_add(tgt, idx, src, axis=0):
    return tgt.clone().index_add_(axis, idx, src)
def _segment_sum(src, seg, n):
    out = torch.zeros((n,) + src.shape[1:], dtype=src.dtype)
    return out.index_add_(0, seg, src)
def _pad(x, pw):
    flat = tuple(v for pair in reversed(pw) for v in pair)
    return torch.nn.functional.pad(x, flat)

kernel_name = 'parallel_sum__gqa_block_cached__glu_gated_reglu__decode'

def setup_inputs():

    _w = (lambda a: (lambda t: t.to(torch.bfloat16) if t.is_floating_point() else t)(torch.as_tensor(a)))
    def _A_setup():
        B, Sq, D = 8, 1, 512
        Hq, Hkv, Sk, Dh = 32, 32, 4096, 128
        assert Hq % Hkv == 0, (Hq, Hkv)
        return {
            "x": _w((lambda *s: torch.randn(*s, dtype=torch.bfloat16) * 0.05)(B, Sq, D)),
            "k_cache": _w((lambda *s: torch.randn(*s, dtype=torch.bfloat16) * 1.6)(B, Hkv, Sk, Dh)),
            "v_cache": _w((lambda *s: torch.randn(*s, dtype=torch.bfloat16) * 0.8)(B, Hkv, Sk, Dh)),
            "wq": _w((lambda *s: torch.randn(*s, dtype=torch.bfloat16) * 1.6)(D, Hq * Dh) * (D ** -0.5)),
            "wo": _w((lambda *s: torch.randn(*s, dtype=torch.bfloat16) * 0.8)(Hq * Dh, D) * ((Hq * Dh) ** -0.5)),
        }
    _A_in = _A_setup()

    def _B_setup():
        B, S, D, F = 8, 1, 512, 1376
        return {
            "x": _w((lambda *s: torch.randn(*s, dtype=torch.bfloat16) * 0.05)(B, S, D)),
            "W_gate": _w((lambda *s: torch.randn(*s, dtype=torch.bfloat16) * 0.4)(D, F) * (2.0 / D) ** 0.5),
            "W_up": _w((lambda *s: torch.randn(*s, dtype=torch.bfloat16) * 0.4)(D, F) * (2.0 / D) ** 0.5),
            "W_down": _w((lambda *s: torch.randn(*s, dtype=torch.bfloat16) * 0.4)(F, D) * (1.0 / F) ** 0.5),
        }
    _B_in = _B_setup()

    return {
        "A_x": _A_in["x"],
        "A_k_cache": _A_in["k_cache"],
        "A_v_cache": _A_in["v_cache"],
        "A_wq": _A_in["wq"],
        "A_wo": _A_in["wo"],
        "B_x": _B_in["x"],
        "B_W_gate": _B_in["W_gate"],
        "B_W_up": _B_in["W_up"],
        "B_W_down": _B_in["W_down"],
    }

def reference(A_x, A_k_cache, A_v_cache, A_wq, A_wo, B_x, B_W_gate, B_W_up, B_W_down):
    def _A_ref(x, k_cache, v_cache, wq, wo):
        B, Sq, D = x.shape
        Hq, Dh = 32, 128
        Hkv = k_cache.shape[1]
        rep = Hq // Hkv
        q = (lambda x, *d: x.permute(*d))((x @ wq).reshape(B, Sq, Hq, Dh), 0, 2, 1, 3)
        k = (lambda x, n, axis: torch.repeat_interleave(x, n, dim=axis))(k_cache, rep, axis=1)
        v = (lambda x, n, axis: torch.repeat_interleave(x, n, dim=axis))(v_cache, rep, axis=1)
        scores = torch.einsum("bhqd,bhkd->bhqk", q, k) * (Dh ** -0.5)
        p = _softmax(scores, axis=-1)
        o = torch.einsum("bhqk,bhkd->bhqd", p, v)
        return (lambda x, *d: x.permute(*d))(o, 0, 2, 1, 3).reshape(B, Sq, Hq * Dh) @ wo

    def _B_ref(x, W_gate, W_up, W_down):
        gate = torch.einsum("bsd,df->bsf", x, W_gate)
        up = torch.einsum("bsd,df->bsf", x, W_up)
        gate = gate * (lambda x, dt: x.to(dt))(gate > 0, gate.dtype)
        h = gate * up
        return torch.einsum("bsf,fd->bsd", h, W_down)

    x = A_x
    xn = _layernorm(x, axis=-1)
    return x + _A_ref(xn, A_k_cache, A_v_cache, A_wq, A_wo) + _B_ref(xn, B_W_gate, B_W_up, B_W_down)
```

```asm
; @launch grid=(256,1,1) block=(1024,1,1) lds=80640
.amdgcn_target "amdgcn-amd-amdhsa--gfx950"
.text
.globl parallel_sum__gqa_block_cached__glu_gated_reglu__decode_kernel
.p2align 8
.type parallel_sum__gqa_block_cached__glu_gated_reglu__decode_kernel,@function
parallel_sum__gqa_block_cached__glu_gated_reglu__decode_kernel:
    s_cmp_ge_u32 s2, 256
    s_cbranch_scc1 L_end
    s_load_dwordx16 s[16:31], s[0:1], 0
    s_load_dwordx8 s[32:39], s[0:1], 64
    s_lshr_b32 s4, s2, 5
    s_and_b32 s5, s2, 31
    v_and_b32 v1, 63, v0
    v_lshrrev_b32 v3, 6, v0
    s_nop 0
    v_readfirstlane_b32 s6, v3
    s_min_u32 s7, s5, 12
    s_mul_i32 s90, s5, 5
    s_add_u32 s90, s90, s7
    s_cmp_lt_u32 s5, 12
    s_cselect_b32 s91, 6, 5
    s_waitcnt lgkmcnt(0)
    s_lshl_b32 s7, s2, 20
    s_add_u32 s40, s18, s7
    s_addc_u32 s41, s19, 0
    s_and_b32 s41, s41, 0xffff
    s_mov_b32 s42, 1048576
    s_mov_b32 s43, 0x00020000
    s_add_u32 s44, s20, s7
    s_addc_u32 s45, s21, 0
    s_and_b32 s45, s45, 0xffff
    s_mov_b32 s46, 1048576
    s_mov_b32 s47, 0x00020000
    s_lshl_b32 s7, s5, 8
    s_sub_u32 s8, 4194304, s7
    s_add_u32 s48, s22, s7
    s_addc_u32 s49, s23, 0
    s_and_b32 s49, s49, 0xffff
    s_mov_b32 s50, s8
    s_mov_b32 s51, 0x00020000
    s_lshl_b32 s7, s5, 17
    s_add_u32 s52, s24, s7
    s_addc_u32 s53, s25, 0
    s_and_b32 s53, s53, 0xffff
    s_mov_b32 s54, 131072
    s_mov_b32 s55, 0x00020000
    s_mov_b32 s56, s28
    s_and_b32 s57, s29, 0xffff
    s_mov_b32 s58, 1409024
    s_mov_b32 s59, 0x00020000
    s_mov_b32 s60, s30
    s_and_b32 s61, s31, 0xffff
    s_mov_b32 s62, 1409024
    s_mov_b32 s63, 0x00020000
    s_mov_b32 s64, s32
    s_and_b32 s65, s33, 0xffff
    s_mov_b32 s66, 1409024
    s_mov_b32 s67, 0x00020000
    s_lshl_b32 s7, s4, 10
    s_add_u32 s68, s16, s7
    s_addc_u32 s69, s17, 0
    s_and_b32 s69, s69, 0xffff
    s_mov_b32 s70, 1024
    s_mov_b32 s71, 0x00020000
    s_add_u32 s72, s34, s7
    s_addc_u32 s73, s35, 0
    s_and_b32 s73, s73, 0xffff
    s_mov_b32 s74, 1024
    s_mov_b32 s75, 0x00020000
    s_mov_b32 s76, s36
    s_and_b32 s77, s37, 0xffff
    s_mov_b32 s78, 256
    s_mov_b32 s79, 0x00020000
    s_mov_b32 s80, s38
    s_and_b32 s81, s39, 0xffff
    s_mov_b32 s82, 524288
    s_mov_b32 s83, 0x00020000
    v_lshlrev_b32 v3, 4, v1
    buffer_load_dwordx4 v[4:7], v3, s[68:71], 0 offen
    s_lshl_b32 s7, s6, 16
    v_add_u32 v2, s7, v3
    v_lshrrev_b32 v8, 4, v1
    s_lshl_b32 s7, s6, 5
    v_add_u32 v8, s7, v8
    v_lshlrev_b32 v9, 13, v8
    v_and_b32 v10, 15, v1
    v_lshl_add_u32 v9, v10, 4, v9
    s_mov_b32 s7, 0
    buffer_load_dwordx4 v[64:67], v9, s[48:51], s7 offen
    s_mov_b32 s7, 32768
    buffer_load_dwordx4 v[68:71], v9, s[48:51], s7 offen
    s_mov_b32 s7, 65536
    buffer_load_dwordx4 v[72:75], v9, s[48:51], s7 offen
    s_mov_b32 s7, 98304
    buffer_load_dwordx4 v[76:79], v9, s[48:51], s7 offen
    s_mov_b32 s7, 131072
    buffer_load_dwordx4 v[80:83], v9, s[48:51], s7 offen
    s_mov_b32 s7, 163840
    buffer_load_dwordx4 v[84:87], v9, s[48:51], s7 offen
    s_mov_b32 s7, 196608
    buffer_load_dwordx4 v[88:91], v9, s[48:51], s7 offen
    s_mov_b32 s7, 229376
    buffer_load_dwordx4 v[92:95], v9, s[48:51], s7 offen
    v_lshrrev_b32 v11, 3, v1
    s_lshl_b32 s7, s6, 3
    v_add_u32 v11, s7, v11
    s_movk_i32 s7, 2752
    v_mul_lo_u32 v12, v11, s7
    v_and_b32 v13, 7, v1
    v_add_u32 v13, s90, v13
    v_lshl_add_u32 v13, v13, 4, v12
    s_lshl_b32 s7, s6, 13
    v_add_u32 v31, s7, v3
    buffer_load_dwordx4 v[32:35], v2, s[40:43], 0 offen nt
    buffer_load_dwordx4 v[36:39], v2, s[40:43], 0 offen offset:1024 nt
    buffer_load_dwordx4 v[40:43], v2, s[40:43], 0 offen offset:2048 nt
    buffer_load_dwordx4 v[44:47], v2, s[40:43], 0 offen offset:3072 nt
    s_mov_b32 s92, 4096
    buffer_load_dwordx4 v[48:51], v2, s[40:43], s92 offen nt
    s_mov_b32 s92, 4096
    buffer_load_dwordx4 v[52:55], v2, s[40:43], s92 offen offset:1024 nt
    s_mov_b32 s92, 4096
    buffer_load_dwordx4 v[56:59], v2, s[40:43], s92 offen offset:2048 nt
    s_mov_b32 s92, 4096
    buffer_load_dwordx4 v[60:63], v2, s[40:43], s92 offen offset:3072 nt
    s_mov_b32 s92, 8192
    buffer_load_dwordx4 v[96:99], v2, s[40:43], s92 offen nt
    s_mov_b32 s92, 8192
    buffer_load_dwordx4 v[100:103], v2, s[40:43], s92 offen offset:1024 nt
    s_mov_b32 s92, 8192
    buffer_load_dwordx4 v[104:107], v2, s[40:43], s92 offen offset:2048 nt
    s_mov_b32 s92, 8192
    buffer_load_dwordx4 v[108:111], v2, s[40:43], s92 offen offset:3072 nt
    s_mov_b32 s92, 12288
    buffer_load_dwordx4 v[112:115], v2, s[40:43], s92 offen nt
    s_mov_b32 s92, 12288
    buffer_load_dwordx4 v[116:119], v2, s[40:43], s92 offen offset:1024 nt
    s_mov_b32 s92, 12288
    buffer_load_dwordx4 v[120:123], v2, s[40:43], s92 offen offset:2048 nt
    s_mov_b32 s92, 12288
    buffer_load_dwordx4 v[124:127], v2, s[40:43], s92 offen offset:3072 nt
    s_waitcnt vmcnt(24)
    v_lshlrev_b32 v8, 16, v4
    v_and_b32 v9, 0xffff0000, v4
    v_lshlrev_b32 v10, 16, v5
    v_and_b32 v11, 0xffff0000, v5
    v_lshlrev_b32 v24, 16, v6
    v_and_b32 v25, 0xffff0000, v6
    v_lshlrev_b32 v26, 16, v7
    v_and_b32 v27, 0xffff0000, v7
    v_add_f32 v28, v8, v9
    v_add_f32 v29, v10, v11
    v_add_f32 v30, v24, v25
    v_add_f32 v28, v28, v29
    v_add_f32 v29, v26, v27
    v_add_f32 v30, v30, v29
    v_add_f32 v28, v28, v30
    s_nop 1
    v_add_f32_dpp v28, v28, v28 row_ror:8 row_mask:0xf bank_mask:0xf
    s_nop 1
    v_add_f32_dpp v28, v28, v28 row_ror:4 row_mask:0xf bank_mask:0xf
    s_nop 1
    v_add_f32_dpp v28, v28, v28 row_ror:2 row_mask:0xf bank_mask:0xf
    s_nop 1
    v_add_f32_dpp v28, v28, v28 row_ror:1 row_mask:0xf bank_mask:0xf
    s_nop 1
    v_readlane_b32 s84, v28, 0
    v_readlane_b32 s85, v28, 16
    v_readlane_b32 s86, v28, 32
    v_readlane_b32 s87, v28, 48
    s_nop 1
    v_mov_b32 v29, s84
    v_add_f32 v29, s85, v29
    v_add_f32 v29, s86, v29
    v_add_f32 v29, s87, v29
    v_mul_f32 v29, 0x3b000000, v29
    v_sub_f32 v4, v8, v29
    v_mul_f32 v28, v4, v4
    v_sub_f32 v4, v9, v29
    v_fmac_f32 v28, v4, v4
    v_sub_f32 v4, v10, v29
    v_fmac_f32 v28, v4, v4
    v_sub_f32 v4, v11, v29
    v_fmac_f32 v28, v4, v4
    v_sub_f32 v4, v24, v29
    v_fmac_f32 v28, v4, v4
    v_sub_f32 v4, v25, v29
    v_fmac_f32 v28, v4, v4
    v_sub_f32 v4, v26, v29
    v_fmac_f32 v28, v4, v4
    v_sub_f32 v4, v27, v29
    v_fmac_f32 v28, v4, v4
    s_nop 1
    v_add_f32_dpp v28, v28, v28 row_ror:8 row_mask:0xf bank_mask:0xf
    s_nop 1
    v_add_f32_dpp v28, v28, v28 row_ror:4 row_mask:0xf bank_mask:0xf
    s_nop 1
    v_add_f32_dpp v28, v28, v28 row_ror:2 row_mask:0xf bank_mask:0xf
    s_nop 1
    v_add_f32_dpp v28, v28, v28 row_ror:1 row_mask:0xf bank_mask:0xf
    s_nop 1
    v_readlane_b32 s84, v28, 0
    v_readlane_b32 s85, v28, 16
    v_readlane_b32 s86, v28, 32
    v_readlane_b32 s87, v28, 48
    s_nop 1
    v_mov_b32 v30, s84
    v_add_f32 v30, s85, v30
    v_add_f32 v30, s86, v30
    v_add_f32 v30, s87, v30
    v_mul_f32 v30, 0x3b000000, v30
    v_cvt_pk_bf16_f32 v29, v29, v29
    v_lshlrev_b32 v29, 16, v29
    v_cvt_pk_bf16_f32 v30, v30, v30
    v_lshlrev_b32 v30, 16, v30
    v_add_f32 v30, 0x3727c5ac, v30
    v_cvt_pk_bf16_f32 v30, v30, v30
    v_lshlrev_b32 v30, 16, v30
    v_sqrt_f32 v30, v30
    s_nop 0
    v_cvt_pk_bf16_f32 v30, v30, v30
    v_lshlrev_b32 v30, 16, v30
    v_rcp_f32 v30, v30
    s_nop 0
    v_sub_f32 v8, v8, v29
    v_cvt_pk_bf16_f32 v8, v8, v8
    v_lshlrev_b32 v8, 16, v8
    v_mul_f32 v8, v8, v30
    v_cvt_pk_bf16_f32 v8, v8, v8
    v_lshlrev_b32 v8, 16, v8
    v_sub_f32 v9, v9, v29
    v_cvt_pk_bf16_f32 v9, v9, v9
    v_lshlrev_b32 v9, 16, v9
    v_mul_f32 v9, v9, v30
    v_cvt_pk_bf16_f32 v9, v9, v9
    v_lshlrev_b32 v9, 16, v9
    v_sub_f32 v10, v10, v29
    v_cvt_pk_bf16_f32 v10, v10, v10
    v_lshlrev_b32 v10, 16, v10
    v_mul_f32 v10, v10, v30
    v_cvt_pk_bf16_f32 v10, v10, v10
    v_lshlrev_b32 v10, 16, v10
    v_sub_f32 v11, v11, v29
    v_cvt_pk_bf16_f32 v11, v11, v11
    v_lshlrev_b32 v11, 16, v11
    v_mul_f32 v11, v11, v30
    v_cvt_pk_bf16_f32 v11, v11, v11
    v_lshlrev_b32 v11, 16, v11
    v_sub_f32 v24, v24, v29
    v_cvt_pk_bf16_f32 v24, v24, v24
    v_lshlrev_b32 v24, 16, v24
    v_mul_f32 v24, v24, v30
    v_cvt_pk_bf16_f32 v24, v24, v24
    v_lshlrev_b32 v24, 16, v24
    v_sub_f32 v25, v25, v29
    v_cvt_pk_bf16_f32 v25, v25, v25
    v_lshlrev_b32 v25, 16, v25
    v_mul_f32 v25, v25, v30
    v_cvt_pk_bf16_f32 v25, v25, v25
    v_lshlrev_b32 v25, 16, v25
    v_sub_f32 v26, v26, v29
    v_cvt_pk_bf16_f32 v26, v26, v26
    v_lshlrev_b32 v26, 16, v26
    v_mul_f32 v26, v26, v30
    v_cvt_pk_bf16_f32 v26, v26, v26
    v_lshlrev_b32 v26, 16, v26
    v_sub_f32 v27, v27, v29
    v_cvt_pk_bf16_f32 v27, v27, v27
    v_lshlrev_b32 v27, 16, v27
    v_mul_f32 v27, v27, v30
    v_cvt_pk_bf16_f32 v27, v27, v27
    v_lshlrev_b32 v27, 16, v27
    v_lshlrev_b32 v3, 5, v1
    ds_write_b128 v3, v[8:11] offset:0
    ds_write_b128 v3, v[24:27] offset:16
    s_waitcnt lgkmcnt(0)
    v_lshrrev_b32 v3, 4, v1
    s_lshl_b32 s7, s6, 5
    v_add_u32 v3, s7, v3
    v_lshlrev_b32 v3, 2, v3
    ds_read_b32 v8, v3 offset:0
    ds_read_b32 v9, v3 offset:16
    ds_read_b32 v10, v3 offset:32
    ds_read_b32 v11, v3 offset:48
    ds_read_b32 v12, v3 offset:64
    ds_read_b32 v14, v3 offset:80
    ds_read_b32 v15, v3 offset:96
    ds_read_b32 v28, v3 offset:112
    v_mov_b32 v20, 0
    v_mov_b32 v21, 0
    v_mov_b32 v22, 0
    v_mov_b32 v23, 0
    v_mov_b32 v24, 0
    v_mov_b32 v25, 0
    v_mov_b32 v26, 0
    v_mov_b32 v27, 0
    s_waitcnt vmcnt(16)
    s_waitcnt lgkmcnt(0)
    v_lshlrev_b32 v4, 16, v64
    v_and_b32 v5, 0xffff0000, v64
    v_fmac_f32 v20, v8, v4
    v_fmac_f32 v21, v8, v5
    v_lshlrev_b32 v4, 16, v65
    v_and_b32 v5, 0xffff0000, v65
    v_fmac_f32 v22, v8, v4
    v_fmac_f32 v23, v8, v5
    v_lshlrev_b32 v4, 16, v66
    v_and_b32 v5, 0xffff0000, v66
    v_fmac_f32 v24, v8, v4
    v_fmac_f32 v25, v8, v5
    v_lshlrev_b32 v4, 16, v67
    v_and_b32 v5, 0xffff0000, v67
    v_fmac_f32 v26, v8, v4
    v_fmac_f32 v27, v8, v5
    v_lshlrev_b32 v4, 16, v68
    v_and_b32 v5, 0xffff0000, v68
    v_fmac_f32 v20, v9, v4
    v_fmac_f32 v21, v9, v5
    v_lshlrev_b32 v4, 16, v69
    v_and_b32 v5, 0xffff0000, v69
    v_fmac_f32 v22, v9, v4
    v_fmac_f32 v23, v9, v5
    v_lshlrev_b32 v4, 16, v70
    v_and_b32 v5, 0xffff0000, v70
    v_fmac_f32 v24, v9, v4
    v_fmac_f32 v25, v9, v5
    v_lshlrev_b32 v4, 16, v71
    v_and_b32 v5, 0xffff0000, v71
    v_fmac_f32 v26, v9, v4
    v_fmac_f32 v27, v9, v5
    v_lshlrev_b32 v4, 16, v72
    v_and_b32 v5, 0xffff0000, v72
    v_fmac_f32 v20, v10, v4
    v_fmac_f32 v21, v10, v5
    v_lshlrev_b32 v4, 16, v73
    v_and_b32 v5, 0xffff0000, v73
    v_fmac_f32 v22, v10, v4
    v_fmac_f32 v23, v10, v5
    v_lshlrev_b32 v4, 16, v74
    v_and_b32 v5, 0xffff0000, v74
    v_fmac_f32 v24, v10, v4
    v_fmac_f32 v25, v10, v5
    v_lshlrev_b32 v4, 16, v75
    v_and_b32 v5, 0xffff0000, v75
    v_fmac_f32 v26, v10, v4
    v_fmac_f32 v27, v10, v5
    v_lshlrev_b32 v4, 16, v76
    v_and_b32 v5, 0xffff0000, v76
    v_fmac_f32 v20, v11, v4
    v_fmac_f32 v21, v11, v5
    v_lshlrev_b32 v4, 16, v77
    v_and_b32 v5, 0xffff0000, v77
    v_fmac_f32 v22, v11, v4
    v_fmac_f32 v23, v11, v5
    v_lshlrev_b32 v4, 16, v78
    v_and_b32 v5, 0xffff0000, v78
    v_fmac_f32 v24, v11, v4
    v_fmac_f32 v25, v11, v5
    v_lshlrev_b32 v4, 16, v79
    v_and_b32 v5, 0xffff0000, v79
    v_fmac_f32 v26, v11, v4
    v_fmac_f32 v27, v11, v5
    v_lshlrev_b32 v4, 16, v80
    v_and_b32 v5, 0xffff0000, v80
    v_fmac_f32 v20, v12, v4
    v_fmac_f32 v21, v12, v5
    v_lshlrev_b32 v4, 16, v81
    v_and_b32 v5, 0xffff0000, v81
    v_fmac_f32 v22, v12, v4
    v_fmac_f32 v23, v12, v5
    v_lshlrev_b32 v4, 16, v82
    v_and_b32 v5, 0xffff0000, v82
    v_fmac_f32 v24, v12, v4
    v_fmac_f32 v25, v12, v5
    v_lshlrev_b32 v4, 16, v83
    v_and_b32 v5, 0xffff0000, v83
    v_fmac_f32 v26, v12, v4
    v_fmac_f32 v27, v12, v5
    v_lshlrev_b32 v4, 16, v84
    v_and_b32 v5, 0xffff0000, v84
    v_fmac_f32 v20, v14, v4
    v_fmac_f32 v21, v14, v5
    v_lshlrev_b32 v4, 16, v85
    v_and_b32 v5, 0xffff0000, v85
    v_fmac_f32 v22, v14, v4
    v_fmac_f32 v23, v14, v5
    v_lshlrev_b32 v4, 16, v86
    v_and_b32 v5, 0xffff0000, v86
    v_fmac_f32 v24, v14, v4
    v_fmac_f32 v25, v14, v5
    v_lshlrev_b32 v4, 16, v87
    v_and_b32 v5, 0xffff0000, v87
    v_fmac_f32 v26, v14, v4
    v_fmac_f32 v27, v14, v5
    v_lshlrev_b32 v4, 16, v88
    v_and_b32 v5, 0xffff0000, v88
    v_fmac_f32 v20, v15, v4
    v_fmac_f32 v21, v15, v5
    v_lshlrev_b32 v4, 16, v89
    v_and_b32 v5, 0xffff0000, v89
    v_fmac_f32 v22, v15, v4
    v_fmac_f32 v23, v15, v5
    v_lshlrev_b32 v4, 16, v90
    v_and_b32 v5, 0xffff0000, v90
    v_fmac_f32 v24, v15, v4
    v_fmac_f32 v25, v15, v5
    v_lshlrev_b32 v4, 16, v91
    v_and_b32 v5, 0xffff0000, v91
    v_fmac_f32 v26, v15, v4
    v_fmac_f32 v27, v15, v5
    v_lshlrev_b32 v4, 16, v92
    v_and_b32 v5, 0xffff0000, v92
    v_fmac_f32 v20, v28, v4
    v_fmac_f32 v21, v28, v5
    v_lshlrev_b32 v4, 16, v93
    v_and_b32 v5, 0xffff0000, v93
    v_fmac_f32 v22, v28, v4
    v_fmac_f32 v23, v28, v5
    v_lshlrev_b32 v4, 16, v94
    v_and_b32 v5, 0xffff0000, v94
    v_fmac_f32 v24, v28, v4
    v_fmac_f32 v25, v28, v5
    v_lshlrev_b32 v4, 16, v95
    v_and_b32 v5, 0xffff0000, v95
    v_fmac_f32 v26, v28, v4
    v_fmac_f32 v27, v28, v5
    v_lshrrev_b32 v4, 4, v1
    s_lshl_b32 s7, s6, 2
    v_add_u32 v4, s7, v4
    v_lshlrev_b32 v4, 9, v4
    v_and_b32 v5, 15, v1
    v_lshl_add_u32 v4, v5, 5, v4
    v_mov_b32 v7, v4
    ds_write_b128 v4, v[20:23] offset:2048
    ds_write_b128 v4, v[24:27] offset:2064
    s_waitcnt lgkmcnt(0)
    s_barrier
    s_cmp_ge_u32 s6, 8
    s_cbranch_scc1 L_st2_done
    v_and_b32 v4, 127, v0
    v_lshrrev_b32 v5, 7, v0
    v_lshlrev_b32 v6, 13, v5
    v_lshl_add_u32 v6, v4, 2, v6
    ds_read_b32 v64, v6 offset:2048
    ds_read_b32 v65, v6 offset:2560
    ds_read_b32 v66, v6 offset:3072
    ds_read_b32 v67, v6 offset:3584
    ds_read_b32 v68, v6 offset:4096
    ds_read_b32 v69, v6 offset:4608
    ds_read_b32 v70, v6 offset:5120
    ds_read_b32 v71, v6 offset:5632
    ds_read_b32 v72, v6 offset:6144
    ds_read_b32 v73, v6 offset:6656
    ds_read_b32 v74, v6 offset:7168
    ds_read_b32 v75, v6 offset:7680
    ds_read_b32 v76, v6 offset:8192
    ds_read_b32 v77, v6 offset:8704
    ds_read_b32 v78, v6 offset:9216
    ds_read_b32 v79, v6 offset:9728
    s_waitcnt lgkmcnt(0)
    v_add_f32 v64, v64, v65
    v_add_f32 v64, v64, v66
    v_add_f32 v64, v64, v67
    v_add_f32 v64, v64, v68
    v_add_f32 v64, v64, v69
    v_add_f32 v64, v64, v70
    v_add_f32 v64, v64, v71
    v_add_f32 v64, v64, v72
    v_add_f32 v64, v64, v73
    v_add_f32 v64, v64, v74
    v_add_f32 v64, v64, v75
    v_add_f32 v64, v64, v76
    v_add_f32 v64, v64, v77
    v_add_f32 v64, v64, v78
    v_add_f32 v64, v64, v79
    v_lshlrev_b32 v6, 9, v5
    v_lshl_add_u32 v6, v4, 2, v6
    v_add_u32 v6, 45056, v6
    ds_write_b32 v6, v64
    s_waitcnt lgkmcnt(0)
L_st2_done:
    s_barrier
    v_and_b32 v4, 15, v1
    v_lshlrev_b32 v4, 5, v4
    v_add_u32 v4, 45056, v4
    ds_read_b128 v[64:67], v4 offset:0
    ds_read_b128 v[68:71], v4 offset:16
    ds_read_b128 v[72:75], v4 offset:512
    ds_read_b128 v[76:79], v4 offset:528
    ds_read_b128 v[80:83], v4 offset:1024
    ds_read_b128 v[84:87], v4 offset:1040
    ds_read_b128 v[88:91], v4 offset:1536
    ds_read_b128 v[92:95], v4 offset:1552
    s_waitcnt lgkmcnt(0)
    v_add_f32 v64, v64, v72
    v_add_f32 v80, v80, v88
    v_add_f32 v64, v64, v80
    v_add_f32 v65, v65, v73
    v_add_f32 v81, v81, v89
    v_add_f32 v65, v65, v81
    v_add_f32 v66, v66, v74
    v_add_f32 v82, v82, v90
    v_add_f32 v66, v66, v82
    v_add_f32 v67, v67, v75
    v_add_f32 v83, v83, v91
    v_add_f32 v67, v67, v83
    v_add_f32 v68, v68, v76
    v_add_f32 v84, v84, v92
    v_add_f32 v68, v68, v84
    v_add_f32 v69, v69, v77
    v_add_f32 v85, v85, v93
    v_add_f32 v69, v69, v85
    v_add_f32 v70, v70, v78
    v_add_f32 v86, v86, v94
    v_add_f32 v70, v70, v86
    v_add_f32 v71, v71, v79
    v_add_f32 v87, v87, v95
    v_add_f32 v71, v71, v87
    v_cvt_pk_bf16_f32 v16, v64, v65
    v_cvt_pk_bf16_f32 v17, v66, v67
    v_cvt_pk_bf16_f32 v18, v68, v69
    v_cvt_pk_bf16_f32 v19, v70, v71
    s_nop 1
    s_waitcnt vmcnt(12)
    v_dot2_f32_bf16 v64, v32, v16, 0
    v_dot2_f32_bf16 v65, v36, v16, 0
    v_dot2_f32_bf16 v66, v40, v16, 0
    v_dot2_f32_bf16 v67, v44, v16, 0
    v_dot2_f32_bf16 v64, v33, v17, v64
    v_dot2_f32_bf16 v65, v37, v17, v65
    v_dot2_f32_bf16 v66, v41, v17, v66
    v_dot2_f32_bf16 v67, v45, v17, v67
    v_dot2_f32_bf16 v64, v34, v18, v64
    v_dot2_f32_bf16 v65, v38, v18, v65
    v_dot2_f32_bf16 v66, v42, v18, v66
    v_dot2_f32_bf16 v67, v46, v18, v67
    v_dot2_f32_bf16 v64, v35, v19, v64
    v_dot2_f32_bf16 v65, v39, v19, v65
    v_dot2_f32_bf16 v66, v43, v19, v66
    v_dot2_f32_bf16 v67, v47, v19, v67
    s_mov_b32 s92, 16384
    buffer_load_dwordx4 v[32:35], v2, s[40:43], s92 offen nt
    s_mov_b32 s92, 16384
    buffer_load_dwordx4 v[36:39], v2, s[40:43], s92 offen offset:1024 nt
    s_mov_b32 s92, 16384
    buffer_load_dwordx4 v[40:43], v2, s[40:43], s92 offen offset:2048 nt
    s_mov_b32 s92, 16384
    buffer_load_dwordx4 v[44:47], v2, s[40:43], s92 offen offset:3072 nt
    v_add_f32_dpp v64, v64, v64 row_ror:8 row_mask:0xf bank_mask:0xf
    v_add_f32_dpp v65, v65, v65 row_ror:8 row_mask:0xf bank_mask:0xf
    v_add_f32_dpp v66, v66, v66 row_ror:8 row_mask:0xf bank_mask:0xf
    v_add_f32_dpp v67, v67, v67 row_ror:8 row_mask:0xf bank_mask:0xf
    v_add_f32_dpp v64, v64, v64 row_ror:4 row_mask:0xf bank_mask:0xf
    v_add_f32_dpp v65, v65, v65 row_ror:4 row_mask:0xf bank_mask:0xf
    v_add_f32_dpp v66, v66, v66 row_ror:4 row_mask:0xf bank_mask:0xf
    v_add_f32_dpp v67, v67, v67 row_ror:4 row_mask:0xf bank_mask:0xf
    v_add_f32_dpp v64, v64, v64 row_ror:2 row_mask:0xf bank_mask:0xf
    v_add_f32_dpp v65, v65, v65 row_ror:2 row_mask:0xf bank_mask:0xf
    v_add_f32_dpp v66, v66, v66 row_ror:2 row_mask:0xf bank_mask:0xf
    v_add_f32_dpp v67, v67, v67 row_ror:2 row_mask:0xf bank_mask:0xf
    v_add_f32_dpp v64, v64, v64 row_ror:1 row_mask:0xf bank_mask:0xf
    v_add_f32_dpp v65, v65, v65 row_ror:1 row_mask:0xf bank_mask:0xf
    v_add_f32_dpp v66, v66, v66 row_ror:1 row_mask:0xf bank_mask:0xf
    v_add_f32_dpp v67, v67, v67 row_ror:1 row_mask:0xf bank_mask:0xf
    v_cvt_pk_bf16_f32 v64, v64, v64
    v_cvt_pk_bf16_f32 v65, v65, v65
    v_cvt_pk_bf16_f32 v66, v66, v66
    v_cvt_pk_bf16_f32 v67, v67, v67
    v_lshlrev_b32 v64, 16, v64
    v_lshlrev_b32 v65, 16, v65
    v_lshlrev_b32 v66, 16, v66
    v_lshlrev_b32 v67, 16, v67
    v_mul_f32 v64, 0x3db504f3, v64
    v_mul_f32 v65, 0x3db504f3, v65
    v_mul_f32 v66, 0x3db504f3, v66
    v_mul_f32 v67, 0x3db504f3, v67
    v_cvt_pk_bf16_f32 v64, v64, v64
    v_cvt_pk_bf16_f32 v65, v65, v65
    v_cvt_pk_bf16_f32 v66, v66, v66
    v_cvt_pk_bf16_f32 v67, v67, v67
    v_lshlrev_b32 v64, 16, v64
    v_lshlrev_b32 v65, 16, v65
    v_lshlrev_b32 v66, 16, v66
    v_lshlrev_b32 v67, 16, v67
    s_waitcnt vmcnt(12)
    v_dot2_f32_bf16 v68, v48, v16, 0
    v_dot2_f32_bf16 v69, v52, v16, 0
    v_dot2_f32_bf16 v70, v56, v16, 0
    v_dot2_f32_bf16 v71, v60, v16, 0
    v_dot2_f32_bf16 v68, v49, v17, v68
    v_dot2_f32_bf16 v69, v53, v17, v69
    v_dot2_f32_bf16 v70, v57, v17, v70
    v_dot2_f32_bf16 v71, v61, v17, v71
    v_dot2_f32_bf16 v68, v50, v18, v68
    v_dot2_f32_bf16 v69, v54, v18, v69
    v_dot2_f32_bf16 v70, v58, v18, v70
    v_dot2_f32_bf16 v71, v62, v18, v71
    v_dot2_f32_bf16 v68, v51, v19, v68
    v_dot2_f32_bf16 v69, v55, v19, v69
    v_dot2_f32_bf16 v70, v59, v19, v70
    v_dot2_f32_bf16 v71, v63, v19, v71
    s_mov_b32 s92, 20480
    buffer_load_dwordx4 v[48:51], v2, s[40:43], s92 offen nt
    s_mov_b32 s92, 20480
    buffer_load_dwordx4 v[52:55], v2, s[40:43], s92 offen offset:1024 nt
    s_mov_b32 s92, 20480
    buffer_load_dwordx4 v[56:59], v2, s[40:43], s92 offen offset:2048 nt
    s_mov_b32 s92, 20480
    buffer_load_dwordx4 v[60:63], v2, s[40:43], s92 offen offset:3072 nt
    v_add_f32_dpp v68, v68, v68 row_ror:8 row_mask:0xf bank_mask:0xf
    v_add_f32_dpp v69, v69, v69 row_ror:8 row_mask:0xf bank_mask:0xf
    v_add_f32_dpp v70, v70, v70 row_ror:8 row_mask:0xf bank_mask:0xf
    v_add_f32_dpp v71, v71, v71 row_ror:8 row_mask:0xf bank_mask:0xf
    v_add_f32_dpp v68, v68, v68 row_ror:4 row_mask:0xf bank_mask:0xf
    v_add_f32_dpp v69, v69, v69 row_ror:4 row_mask:0xf bank_mask:0xf
    v_add_f32_dpp v70, v70, v70 row_ror:4 row_mask:0xf bank_mask:0xf
    v_add_f32_dpp v71, v71, v71 row_ror:4 row_mask:0xf bank_mask:0xf
    v_add_f32_dpp v68, v68, v68 row_ror:2 row_mask:0xf bank_mask:0xf
    v_add_f32_dpp v69, v69, v69 row_ror:2 row_mask:0xf bank_mask:0xf
    v_add_f32_dpp v70, v70, v70 row_ror:2 row_mask:0xf bank_mask:0xf
    v_add_f32_dpp v71, v71, v71 row_ror:2 row_mask:0xf bank_mask:0xf
    v_add_f32_dpp v68, v68, v68 row_ror:1 row_mask:0xf bank_mask:0xf
    v_add_f32_dpp v69, v69, v69 row_ror:1 row_mask:0xf bank_mask:0xf
    v_add_f32_dpp v70, v70, v70 row_ror:1 row_mask:0xf bank_mask:0xf
    v_add_f32_dpp v71, v71, v71 row_ror:1 row_mask:0xf bank_mask:0xf
    v_cvt_pk_bf16_f32 v68, v68, v68
    v_cvt_pk_bf16_f32 v69, v69, v69
    v_cvt_pk_bf16_f32 v70, v70, v70
    v_cvt_pk_bf16_f32 v71, v71, v71
    v_lshlrev_b32 v68, 16, v68
    v_lshlrev_b32 v69, 16, v69
    v_lshlrev_b32 v70, 16, v70
    v_lshlrev_b32 v71, 16, v71
    v_mul_f32 v68, 0x3db504f3, v68
    v_mul_f32 v69, 0x3db504f3, v69
    v_mul_f32 v70, 0x3db504f3, v70
    v_mul_f32 v71, 0x3db504f3, v71
    v_cvt_pk_bf16_f32 v68, v68, v68
    v_cvt_pk_bf16_f32 v69, v69, v69
    v_cvt_pk_bf16_f32 v70, v70, v70
    v_cvt_pk_bf16_f32 v71, v71, v71
    v_lshlrev_b32 v68, 16, v68
    v_lshlrev_b32 v69, 16, v69
    v_lshlrev_b32 v70, 16, v70
    v_lshlrev_b32 v71, 16, v71
    s_waitcnt vmcnt(12)
    v_dot2_f32_bf16 v72, v96, v16, 0
    v_dot2_f32_bf16 v73, v100, v16, 0
    v_dot2_f32_bf16 v74, v104, v16, 0
    v_dot2_f32_bf16 v75, v108, v16, 0
    v_dot2_f32_bf16 v72, v97, v17, v72
    v_dot2_f32_bf16 v73, v101, v17, v73
    v_dot2_f32_bf16 v74, v105, v17, v74
    v_dot2_f32_bf16 v75, v109, v17, v75
    v_dot2_f32_bf16 v72, v98, v18, v72
    v_dot2_f32_bf16 v73, v102, v18, v73
    v_dot2_f32_bf16 v74, v106, v18, v74
    v_dot2_f32_bf16 v75, v110, v18, v75
    v_dot2_f32_bf16 v72, v99, v19, v72
    v_dot2_f32_bf16 v73, v103, v19, v73
    v_dot2_f32_bf16 v74, v107, v19, v74
    v_dot2_f32_bf16 v75, v111, v19, v75
    s_mov_b32 s92, 24576
    buffer_load_dwordx4 v[96:99], v2, s[40:43], s92 offen nt
    s_mov_b32 s92, 24576
    buffer_load_dwordx4 v[100:103], v2, s[40:43], s92 offen offset:1024 nt
    s_mov_b32 s92, 24576
    buffer_load_dwordx4 v[104:107], v2, s[40:43], s92 offen offset:2048 nt
    s_mov_b32 s92, 24576
    buffer_load_dwordx4 v[108:111], v2, s[40:43], s92 offen offset:3072 nt
    v_add_f32_dpp v72, v72, v72 row_ror:8 row_mask:0xf bank_mask:0xf
    v_add_f32_dpp v73, v73, v73 row_ror:8 row_mask:0xf bank_mask:0xf
    v_add_f32_dpp v74, v74, v74 row_ror:8 row_mask:0xf bank_mask:0xf
    v_add_f32_dpp v75, v75, v75 row_ror:8 row_mask:0xf bank_mask:0xf
    v_add_f32_dpp v72, v72, v72 row_ror:4 row_mask:0xf bank_mask:0xf
    v_add_f32_dpp v73, v73, v73 row_ror:4 row_mask:0xf bank_mask:0xf
    v_add_f32_dpp v74, v74, v74 row_ror:4 row_mask:0xf bank_mask:0xf
    v_add_f32_dpp v75, v75, v75 row_ror:4 row_mask:0xf bank_mask:0xf
    v_add_f32_dpp v72, v72, v72 row_ror:2 row_mask:0xf bank_mask:0xf
    v_add_f32_dpp v73, v73, v73 row_ror:2 row_mask:0xf bank_mask:0xf
    v_add_f32_dpp v74, v74, v74 row_ror:2 row_mask:0xf bank_mask:0xf
    v_add_f32_dpp v75, v75, v75 row_ror:2 row_mask:0xf bank_mask:0xf
    v_add_f32_dpp v72, v72, v72 row_ror:1 row_mask:0xf bank_mask:0xf
    v_add_f32_dpp v73, v73, v73 row_ror:1 row_mask:0xf bank_mask:0xf
    v_add_f32_dpp v74, v74, v74 row_ror:1 row_mask:0xf bank_mask:0xf
    v_add_f32_dpp v75, v75, v75 row_ror:1 row_mask:0xf bank_mask:0xf
    v_cvt_pk_bf16_f32 v72, v72, v72
    v_cvt_pk_bf16_f32 v73, v73, v73
    v_cvt_pk_bf16_f32 v74, v74, v74
    v_cvt_pk_bf16_f32 v75, v75, v75
    v_lshlrev_b32 v72, 16, v72
    v_lshlrev_b32 v73, 16, v73
    v_lshlrev_b32 v74, 16, v74
    v_lshlrev_b32 v75, 16, v75
    v_mul_f32 v72, 0x3db504f3, v72
    v_mul_f32 v73, 0x3db504f3, v73
    v_mul_f32 v74, 0x3db504f3, v74
    v_mul_f32 v75, 0x3db504f3, v75
    v_cvt_pk_bf16_f32 v72, v72, v72
    v_cvt_pk_bf16_f32 v73, v73, v73
    v_cvt_pk_bf16_f32 v74, v74, v74
    v_cvt_pk_bf16_f32 v75, v75, v75
    v_lshlrev_b32 v72, 16, v72
    v_lshlrev_b32 v73, 16, v73
    v_lshlrev_b32 v74, 16, v74
    v_lshlrev_b32 v75, 16, v75
    s_waitcnt vmcnt(12)
    v_dot2_f32_bf16 v76, v112, v16, 0
    v_dot2_f32_bf16 v77, v116, v16, 0
    v_dot2_f32_bf16 v78, v120, v16, 0
    v_dot2_f32_bf16 v79, v124, v16, 0
    v_dot2_f32_bf16 v76, v113, v17, v76
    v_dot2_f32_bf16 v77, v117, v17, v77
    v_dot2_f32_bf16 v78, v121, v17, v78
    v_dot2_f32_bf16 v79, v125, v17, v79
    v_dot2_f32_bf16 v76, v114, v18, v76
    v_dot2_f32_bf16 v77, v118, v18, v77
    v_dot2_f32_bf16 v78, v122, v18, v78
    v_dot2_f32_bf16 v79, v126, v18, v79
    v_dot2_f32_bf16 v76, v115, v19, v76
    v_dot2_f32_bf16 v77, v119, v19, v77
    v_dot2_f32_bf16 v78, v123, v19, v78
    v_dot2_f32_bf16 v79, v127, v19, v79
    s_mov_b32 s92, 28672
    buffer_load_dwordx4 v[112:115], v2, s[40:43], s92 offen nt
    s_mov_b32 s92, 28672
    buffer_load_dwordx4 v[116:119], v2, s[40:43], s92 offen offset:1024 nt
    s_mov_b32 s92, 28672
    buffer_load_dwordx4 v[120:123], v2, s[40:43], s92 offen offset:2048 nt
    s_mov_b32 s92, 28672
    buffer_load_dwordx4 v[124:127], v2, s[40:43], s92 offen offset:3072 nt
    v_add_f32_dpp v76, v76, v76 row_ror:8 row_mask:0xf bank_mask:0xf
    v_add_f32_dpp v77, v77, v77 row_ror:8 row_mask:0xf bank_mask:0xf
    v_add_f32_dpp v78, v78, v78 row_ror:8 row_mask:0xf bank_mask:0xf
    v_add_f32_dpp v79, v79, v79 row_ror:8 row_mask:0xf bank_mask:0xf
    v_add_f32_dpp v76, v76, v76 row_ror:4 row_mask:0xf bank_mask:0xf
    v_add_f32_dpp v77, v77, v77 row_ror:4 row_mask:0xf bank_mask:0xf
    v_add_f32_dpp v78, v78, v78 row_ror:4 row_mask:0xf bank_mask:0xf
    v_add_f32_dpp v79, v79, v79 row_ror:4 row_mask:0xf bank_mask:0xf
    v_add_f32_dpp v76, v76, v76 row_ror:2 row_mask:0xf bank_mask:0xf
    v_add_f32_dpp v77, v77, v77 row_ror:2 row_mask:0xf bank_mask:0xf
    v_add_f32_dpp v78, v78, v78 row_ror:2 row_mask:0xf bank_mask:0xf
    v_add_f32_dpp v79, v79, v79 row_ror:2 row_mask:0xf bank_mask:0xf
    v_add_f32_dpp v76, v76, v76 row_ror:1 row_mask:0xf bank_mask:0xf
    v_add_f32_dpp v77, v77, v77 row_ror:1 row_mask:0xf bank_mask:0xf
    v_add_f32_dpp v78, v78, v78 row_ror:1 row_mask:0xf bank_mask:0xf
    v_add_f32_dpp v79, v79, v79 row_ror:1 row_mask:0xf bank_mask:0xf
    v_cvt_pk_bf16_f32 v76, v76, v76
    v_cvt_pk_bf16_f32 v77, v77, v77
    v_cvt_pk_bf16_f32 v78, v78, v78
    v_cvt_pk_bf16_f32 v79, v79, v79
    v_lshlrev_b32 v76, 16, v76
    v_lshlrev_b32 v77, 16, v77
    v_lshlrev_b32 v78, 16, v78
    v_lshlrev_b32 v79, 16, v79
    v_mul_f32 v76, 0x3db504f3, v76
    v_mul_f32 v77, 0x3db504f3, v77
    v_mul_f32 v78, 0x3db504f3, v78
    v_mul_f32 v79, 0x3db504f3, v79
    v_cvt_pk_bf16_f32 v76, v76, v76
    v_cvt_pk_bf16_f32 v77, v77, v77
    v_cvt_pk_bf16_f32 v78, v78, v78
    v_cvt_pk_bf16_f32 v79, v79, v79
    v_lshlrev_b32 v76, 16, v76
    v_lshlrev_b32 v77, 16, v77
    v_lshlrev_b32 v78, 16, v78
    v_lshlrev_b32 v79, 16, v79
    s_waitcnt vmcnt(12)
    v_dot2_f32_bf16 v80, v32, v16, 0
    v_dot2_f32_bf16 v81, v36, v16, 0
    v_dot2_f32_bf16 v82, v40, v16, 0
    v_dot2_f32_bf16 v83, v44, v16, 0
    v_dot2_f32_bf16 v80, v33, v17, v80
    v_dot2_f32_bf16 v81, v37, v17, v81
    v_dot2_f32_bf16 v82, v41, v17, v82
    v_dot2_f32_bf16 v83, v45, v17, v83
    v_dot2_f32_bf16 v80, v34, v18, v80
    v_dot2_f32_bf16 v81, v38, v18, v81
    v_dot2_f32_bf16 v82, v42, v18, v82
    v_dot2_f32_bf16 v83, v46, v18, v83
    v_dot2_f32_bf16 v80, v35, v19, v80
    v_dot2_f32_bf16 v81, v39, v19, v81
    v_dot2_f32_bf16 v82, v43, v19, v82
    v_dot2_f32_bf16 v83, v47, v19, v83
    s_mov_b32 s92, 32768
    buffer_load_dwordx4 v[32:35], v2, s[40:43], s92 offen nt
    s_mov_b32 s92, 32768
    buffer_load_dwordx4 v[36:39], v2, s[40:43], s92 offen offset:1024 nt
    s_mov_b32 s92, 32768
    buffer_load_dwordx4 v[40:43], v2, s[40:43], s92 offen offset:2048 nt
    s_mov_b32 s92, 32768
    buffer_load_dwordx4 v[44:47], v2, s[40:43], s92 offen offset:3072 nt
    v_add_f32_dpp v80, v80, v80 row_ror:8 row_mask:0xf bank_mask:0xf
    v_add_f32_dpp v81, v81, v81 row_ror:8 row_mask:0xf bank_mask:0xf
    v_add_f32_dpp v82, v82, v82 row_ror:8 row_mask:0xf bank_mask:0xf
    v_add_f32_dpp v83, v83, v83 row_ror:8 row_mask:0xf bank_mask:0xf
    v_add_f32_dpp v80, v80, v80 row_ror:4 row_mask:0xf bank_mask:0xf
    v_add_f32_dpp v81, v81, v81 row_ror:4 row_mask:0xf bank_mask:0xf
    v_add_f32_dpp v82, v82, v82 row_ror:4 row_mask:0xf bank_mask:0xf
    v_add_f32_dpp v83, v83, v83 row_ror:4 row_mask:0xf bank_mask:0xf
    v_add_f32_dpp v80, v80, v80 row_ror:2 row_mask:0xf bank_mask:0xf
    v_add_f32_dpp v81, v81, v81 row_ror:2 row_mask:0xf bank_mask:0xf
    v_add_f32_dpp v82, v82, v82 row_ror:2 row_mask:0xf bank_mask:0xf
    v_add_f32_dpp v83, v83, v83 row_ror:2 row_mask:0xf bank_mask:0xf
    v_add_f32_dpp v80, v80, v80 row_ror:1 row_mask:0xf bank_mask:0xf
    v_add_f32_dpp v81, v81, v81 row_ror:1 row_mask:0xf bank_mask:0xf
    v_add_f32_dpp v82, v82, v82 row_ror:1 row_mask:0xf bank_mask:0xf
    v_add_f32_dpp v83, v83, v83 row_ror:1 row_mask:0xf bank_mask:0xf
    v_cvt_pk_bf16_f32 v80, v80, v80
    v_cvt_pk_bf16_f32 v81, v81, v81
    v_cvt_pk_bf16_f32 v82, v82, v82
    v_cvt_pk_bf16_f32 v83, v83, v83
    v_lshlrev_b32 v80, 16, v80
    v_lshlrev_b32 v81, 16, v81
    v_lshlrev_b32 v82, 16, v82
    v_lshlrev_b32 v83, 16, v83
    v_mul_f32 v80, 0x3db504f3, v80
    v_mul_f32 v81, 0x3db504f3, v81
    v_mul_f32 v82, 0x3db504f3, v82
    v_mul_f32 v83, 0x3db504f3, v83
    v_cvt_pk_bf16_f32 v80, v80, v80
    v_cvt_pk_bf16_f32 v81, v81, v81
    v_cvt_pk_bf16_f32 v82, v82, v82
    v_cvt_pk_bf16_f32 v83, v83, v83
    v_lshlrev_b32 v80, 16, v80
    v_lshlrev_b32 v81, 16, v81
    v_lshlrev_b32 v82, 16, v82
    v_lshlrev_b32 v83, 16, v83
    s_waitcnt vmcnt(12)
    v_dot2_f32_bf16 v84, v48, v16, 0
    v_dot2_f32_bf16 v85, v52, v16, 0
    v_dot2_f32_bf16 v86, v56, v16, 0
    v_dot2_f32_bf16 v87, v60, v16, 0
    v_dot2_f32_bf16 v84, v49, v17, v84
    v_dot2_f32_bf16 v85, v53, v17, v85
    v_dot2_f32_bf16 v86, v57, v17, v86
    v_dot2_f32_bf16 v87, v61, v17, v87
    v_dot2_f32_bf16 v84, v50, v18, v84
    v_dot2_f32_bf16 v85, v54, v18, v85
    v_dot2_f32_bf16 v86, v58, v18, v86
    v_dot2_f32_bf16 v87, v62, v18, v87
    v_dot2_f32_bf16 v84, v51, v19, v84
    v_dot2_f32_bf16 v85, v55, v19, v85
    v_dot2_f32_bf16 v86, v59, v19, v86
    v_dot2_f32_bf16 v87, v63, v19, v87
    s_mov_b32 s92, 36864
    buffer_load_dwordx4 v[48:51], v2, s[40:43], s92 offen nt
    s_mov_b32 s92, 36864
    buffer_load_dwordx4 v[52:55], v2, s[40:43], s92 offen offset:1024 nt
    s_mov_b32 s92, 36864
    buffer_load_dwordx4 v[56:59], v2, s[40:43], s92 offen offset:2048 nt
    s_mov_b32 s92, 36864
    buffer_load_dwordx4 v[60:63], v2, s[40:43], s92 offen offset:3072 nt
    v_add_f32_dpp v84, v84, v84 row_ror:8 row_mask:0xf bank_mask:0xf
    v_add_f32_dpp v85, v85, v85 row_ror:8 row_mask:0xf bank_mask:0xf
    v_add_f32_dpp v86, v86, v86 row_ror:8 row_mask:0xf bank_mask:0xf
    v_add_f32_dpp v87, v87, v87 row_ror:8 row_mask:0xf bank_mask:0xf
    v_add_f32_dpp v84, v84, v84 row_ror:4 row_mask:0xf bank_mask:0xf
    v_add_f32_dpp v85, v85, v85 row_ror:4 row_mask:0xf bank_mask:0xf
    v_add_f32_dpp v86, v86, v86 row_ror:4 row_mask:0xf bank_mask:0xf
    v_add_f32_dpp v87, v87, v87 row_ror:4 row_mask:0xf bank_mask:0xf
    v_add_f32_dpp v84, v84, v84 row_ror:2 row_mask:0xf bank_mask:0xf
    v_add_f32_dpp v85, v85, v85 row_ror:2 row_mask:0xf bank_mask:0xf
    v_add_f32_dpp v86, v86, v86 row_ror:2 row_mask:0xf bank_mask:0xf
    v_add_f32_dpp v87, v87, v87 row_ror:2 row_mask:0xf bank_mask:0xf
    v_add_f32_dpp v84, v84, v84 row_ror:1 row_mask:0xf bank_mask:0xf
    v_add_f32_dpp v85, v85, v85 row_ror:1 row_mask:0xf bank_mask:0xf
    v_add_f32_dpp v86, v86, v86 row_ror:1 row_mask:0xf bank_mask:0xf
    v_add_f32_dpp v87, v87, v87 row_ror:1 row_mask:0xf bank_mask:0xf
    v_cvt_pk_bf16_f32 v84, v84, v84
    v_cvt_pk_bf16_f32 v85, v85, v85
    v_cvt_pk_bf16_f32 v86, v86, v86
    v_cvt_pk_bf16_f32 v87, v87, v87
    v_lshlrev_b32 v84, 16, v84
    v_lshlrev_b32 v85, 16, v85
    v_lshlrev_b32 v86, 16, v86
    v_lshlrev_b32 v87, 16, v87
    v_mul_f32 v84, 0x3db504f3, v84
    v_mul_f32 v85, 0x3db504f3, v85
    v_mul_f32 v86, 0x3db504f3, v86
    v_mul_f32 v87, 0x3db504f3, v87
    v_cvt_pk_bf16_f32 v84, v84, v84
    v_cvt_pk_bf16_f32 v85, v85, v85
    v_cvt_pk_bf16_f32 v86, v86, v86
    v_cvt_pk_bf16_f32 v87, v87, v87
    v_lshlrev_b32 v84, 16, v84
    v_lshlrev_b32 v85, 16, v85
    v_lshlrev_b32 v86, 16, v86
    v_lshlrev_b32 v87, 16, v87
    s_waitcnt vmcnt(12)
    v_dot2_f32_bf16 v88, v96, v16, 0
    v_dot2_f32_bf16 v89, v100, v16, 0
    v_dot2_f32_bf16 v90, v104, v16, 0
    v_dot2_f32_bf16 v91, v108, v16, 0
    v_dot2_f32_bf16 v88, v97, v17, v88
    v_dot2_f32_bf16 v89, v101, v17, v89
    v_dot2_f32_bf16 v90, v105, v17, v90
    v_dot2_f32_bf16 v91, v109, v17, v91
    v_dot2_f32_bf16 v88, v98, v18, v88
    v_dot2_f32_bf16 v89, v102, v18, v89
    v_dot2_f32_bf16 v90, v106, v18, v90
    v_dot2_f32_bf16 v91, v110, v18, v91
    v_dot2_f32_bf16 v88, v99, v19, v88
    v_dot2_f32_bf16 v89, v103, v19, v89
    v_dot2_f32_bf16 v90, v107, v19, v90
    v_dot2_f32_bf16 v91, v111, v19, v91
    v_add_f32_dpp v88, v88, v88 row_ror:8 row_mask:0xf bank_mask:0xf
    v_add_f32_dpp v89, v89, v89 row_ror:8 row_mask:0xf bank_mask:0xf
    v_add_f32_dpp v90, v90, v90 row_ror:8 row_mask:0xf bank_mask:0xf
    v_add_f32_dpp v91, v91, v91 row_ror:8 row_mask:0xf bank_mask:0xf
    v_add_f32_dpp v88, v88, v88 row_ror:4 row_mask:0xf bank_mask:0xf
    v_add_f32_dpp v89, v89, v89 row_ror:4 row_mask:0xf bank_mask:0xf
    v_add_f32_dpp v90, v90, v90 row_ror:4 row_mask:0xf bank_mask:0xf
    v_add_f32_dpp v91, v91, v91 row_ror:4 row_mask:0xf bank_mask:0xf
    v_add_f32_dpp v88, v88, v88 row_ror:2 row_mask:0xf bank_mask:0xf
    v_add_f32_dpp v89, v89, v89 row_ror:2 row_mask:0xf bank_mask:0xf
    v_add_f32_dpp v90, v90, v90 row_ror:2 row_mask:0xf bank_mask:0xf
    v_add_f32_dpp v91, v91, v91 row_ror:2 row_mask:0xf bank_mask:0xf
    v_add_f32_dpp v88, v88, v88 row_ror:1 row_mask:0xf bank_mask:0xf
    v_add_f32_dpp v89, v89, v89 row_ror:1 row_mask:0xf bank_mask:0xf
    v_add_f32_dpp v90, v90, v90 row_ror:1 row_mask:0xf bank_mask:0xf
    v_add_f32_dpp v91, v91, v91 row_ror:1 row_mask:0xf bank_mask:0xf
    v_cvt_pk_bf16_f32 v88, v88, v88
    v_cvt_pk_bf16_f32 v89, v89, v89
    v_cvt_pk_bf16_f32 v90, v90, v90
    v_cvt_pk_bf16_f32 v91, v91, v91
    v_lshlrev_b32 v88, 16, v88
    v_lshlrev_b32 v89, 16, v89
    v_lshlrev_b32 v90, 16, v90
    v_lshlrev_b32 v91, 16, v91
    v_mul_f32 v88, 0x3db504f3, v88
    v_mul_f32 v89, 0x3db504f3, v89
    v_mul_f32 v90, 0x3db504f3, v90
    v_mul_f32 v91, 0x3db504f3, v91
    v_cvt_pk_bf16_f32 v88, v88, v88
    v_cvt_pk_bf16_f32 v89, v89, v89
    v_cvt_pk_bf16_f32 v90, v90, v90
    v_cvt_pk_bf16_f32 v91, v91, v91
    v_lshlrev_b32 v88, 16, v88
    v_lshlrev_b32 v89, 16, v89
    v_lshlrev_b32 v90, 16, v90
    v_lshlrev_b32 v91, 16, v91
    s_waitcnt vmcnt(8)
    v_dot2_f32_bf16 v92, v112, v16, 0
    v_dot2_f32_bf16 v93, v116, v16, 0
    v_dot2_f32_bf16 v94, v120, v16, 0
    v_dot2_f32_bf16 v95, v124, v16, 0
    v_dot2_f32_bf16 v92, v113, v17, v92
    v_dot2_f32_bf16 v93, v117, v17, v93
    v_dot2_f32_bf16 v94, v121, v17, v94
    v_dot2_f32_bf16 v95, v125, v17, v95
    v_dot2_f32_bf16 v92, v114, v18, v92
    v_dot2_f32_bf16 v93, v118, v18, v93
    v_dot2_f32_bf16 v94, v122, v18, v94
    v_dot2_f32_bf16 v95, v126, v18, v95
    v_dot2_f32_bf16 v92, v115, v19, v92
    v_dot2_f32_bf16 v93, v119, v19, v93
    v_dot2_f32_bf16 v94, v123, v19, v94
    v_dot2_f32_bf16 v95, v127, v19, v95
    v_add_f32_dpp v92, v92, v92 row_ror:8 row_mask:0xf bank_mask:0xf
    v_add_f32_dpp v93, v93, v93 row_ror:8 row_mask:0xf bank_mask:0xf
    v_add_f32_dpp v94, v94, v94 row_ror:8 row_mask:0xf bank_mask:0xf
    v_add_f32_dpp v95, v95, v95 row_ror:8 row_mask:0xf bank_mask:0xf
    v_add_f32_dpp v92, v92, v92 row_ror:4 row_mask:0xf bank_mask:0xf
    v_add_f32_dpp v93, v93, v93 row_ror:4 row_mask:0xf bank_mask:0xf
    v_add_f32_dpp v94, v94, v94 row_ror:4 row_mask:0xf bank_mask:0xf
    v_add_f32_dpp v95, v95, v95 row_ror:4 row_mask:0xf bank_mask:0xf
    v_add_f32_dpp v92, v92, v92 row_ror:2 row_mask:0xf bank_mask:0xf
    v_add_f32_dpp v93, v93, v93 row_ror:2 row_mask:0xf bank_mask:0xf
    v_add_f32_dpp v94, v94, v94 row_ror:2 row_mask:0xf bank_mask:0xf
    v_add_f32_dpp v95, v95, v95 row_ror:2 row_mask:0xf bank_mask:0xf
    v_add_f32_dpp v92, v92, v92 row_ror:1 row_mask:0xf bank_mask:0xf
    v_add_f32_dpp v93, v93, v93 row_ror:1 row_mask:0xf bank_mask:0xf
    v_add_f32_dpp v94, v94, v94 row_ror:1 row_mask:0xf bank_mask:0xf
    v_add_f32_dpp v95, v95, v95 row_ror:1 row_mask:0xf bank_mask:0xf
    v_cvt_pk_bf16_f32 v92, v92, v92
    v_cvt_pk_bf16_f32 v93, v93, v93
    v_cvt_pk_bf16_f32 v94, v94, v94
    v_cvt_pk_bf16_f32 v95, v95, v95
    v_lshlrev_b32 v92, 16, v92
    v_lshlrev_b32 v93, 16, v93
    v_lshlrev_b32 v94, 16, v94
    v_lshlrev_b32 v95, 16, v95
    v_mul_f32 v92, 0x3db504f3, v92
    v_mul_f32 v93, 0x3db504f3, v93
    v_mul_f32 v94, 0x3db504f3, v94
    v_mul_f32 v95, 0x3db504f3, v95
    v_cvt_pk_bf16_f32 v92, v92, v92
    v_cvt_pk_bf16_f32 v93, v93, v93
    v_cvt_pk_bf16_f32 v94, v94, v94
    v_cvt_pk_bf16_f32 v95, v95, v95
    v_lshlrev_b32 v92, 16, v92
    v_lshlrev_b32 v93, 16, v93
    v_lshlrev_b32 v94, 16, v94
    v_lshlrev_b32 v95, 16, v95
    s_waitcnt vmcnt(4)
    v_dot2_f32_bf16 v96, v32, v16, 0
    v_dot2_f32_bf16 v97, v36, v16, 0
    v_dot2_f32_bf16 v98, v40, v16, 0
    v_dot2_f32_bf16 v99, v44, v16, 0
    v_dot2_f32_bf16 v96, v33, v17, v96
    v_dot2_f32_bf16 v97, v37, v17, v97
    v_dot2_f32_bf16 v98, v41, v17, v98
    v_dot2_f32_bf16 v99, v45, v17, v99
    v_dot2_f32_bf16 v96, v34, v18, v96
    v_dot2_f32_bf16 v97, v38, v18, v97
    v_dot2_f32_bf16 v98, v42, v18, v98
    v_dot2_f32_bf16 v99, v46, v18, v99
    v_dot2_f32_bf16 v96, v35, v19, v96
    v_dot2_f32_bf16 v97, v39, v19, v97
    v_dot2_f32_bf16 v98, v43, v19, v98
    v_dot2_f32_bf16 v99, v47, v19, v99
    s_mov_b32 s92, 40960
    buffer_load_dwordx4 v[32:35], v2, s[40:43], s92 offen nt
    s_mov_b32 s92, 40960
    buffer_load_dwordx4 v[36:39], v2, s[40:43], s92 offen offset:1024 nt
    s_mov_b32 s92, 40960
    buffer_load_dwordx4 v[40:43], v2, s[40:43], s92 offen offset:2048 nt
    s_mov_b32 s92, 40960
    buffer_load_dwordx4 v[44:47], v2, s[40:43], s92 offen offset:3072 nt
    v_add_f32_dpp v96, v96, v96 row_ror:8 row_mask:0xf bank_mask:0xf
    v_add_f32_dpp v97, v97, v97 row_ror:8 row_mask:0xf bank_mask:0xf
    v_add_f32_dpp v98, v98, v98 row_ror:8 row_mask:0xf bank_mask:0xf
    v_add_f32_dpp v99, v99, v99 row_ror:8 row_mask:0xf bank_mask:0xf
    v_add_f32_dpp v96, v96, v96 row_ror:4 row_mask:0xf bank_mask:0xf
    v_add_f32_dpp v97, v97, v97 row_ror:4 row_mask:0xf bank_mask:0xf
    v_add_f32_dpp v98, v98, v98 row_ror:4 row_mask:0xf bank_mask:0xf
    v_add_f32_dpp v99, v99, v99 row_ror:4 row_mask:0xf bank_mask:0xf
    v_add_f32_dpp v96, v96, v96 row_ror:2 row_mask:0xf bank_mask:0xf
    v_add_f32_dpp v97, v97, v97 row_ror:2 row_mask:0xf bank_mask:0xf
    v_add_f32_dpp v98, v98, v98 row_ror:2 row_mask:0xf bank_mask:0xf
    v_add_f32_dpp v99, v99, v99 row_ror:2 row_mask:0xf bank_mask:0xf
    v_add_f32_dpp v96, v96, v96 row_ror:1 row_mask:0xf bank_mask:0xf
    v_add_f32_dpp v97, v97, v97 row_ror:1 row_mask:0xf bank_mask:0xf
    v_add_f32_dpp v98, v98, v98 row_ror:1 row_mask:0xf bank_mask:0xf
    v_add_f32_dpp v99, v99, v99 row_ror:1 row_mask:0xf bank_mask:0xf
    v_cvt_pk_bf16_f32 v96, v96, v96
    v_cvt_pk_bf16_f32 v97, v97, v97
    v_cvt_pk_bf16_f32 v98, v98, v98
    v_cvt_pk_bf16_f32 v99, v99, v99
    v_lshlrev_b32 v96, 16, v96
    v_lshlrev_b32 v97, 16, v97
    v_lshlrev_b32 v98, 16, v98
    v_lshlrev_b32 v99, 16, v99
    v_mul_f32 v96, 0x3db504f3, v96
    v_mul_f32 v97, 0x3db504f3, v97
    v_mul_f32 v98, 0x3db504f3, v98
    v_mul_f32 v99, 0x3db504f3, v99
    v_cvt_pk_bf16_f32 v96, v96, v96
    v_cvt_pk_bf16_f32 v97, v97, v97
    v_cvt_pk_bf16_f32 v98, v98, v98
    v_cvt_pk_bf16_f32 v99, v99, v99
    v_lshlrev_b32 v96, 16, v96
    v_lshlrev_b32 v97, 16, v97
    v_lshlrev_b32 v98, 16, v98
    v_lshlrev_b32 v99, 16, v99
    s_waitcnt vmcnt(4)
    v_dot2_f32_bf16 v100, v48, v16, 0
    v_dot2_f32_bf16 v101, v52, v16, 0
    v_dot2_f32_bf16 v102, v56, v16, 0
    v_dot2_f32_bf16 v103, v60, v16, 0
    v_dot2_f32_bf16 v100, v49, v17, v100
    v_dot2_f32_bf16 v101, v53, v17, v101
    v_dot2_f32_bf16 v102, v57, v17, v102
    v_dot2_f32_bf16 v103, v61, v17, v103
    v_dot2_f32_bf16 v100, v50, v18, v100
    v_dot2_f32_bf16 v101, v54, v18, v101
    v_dot2_f32_bf16 v102, v58, v18, v102
    v_dot2_f32_bf16 v103, v62, v18, v103
    v_dot2_f32_bf16 v100, v51, v19, v100
    v_dot2_f32_bf16 v101, v55, v19, v101
    v_dot2_f32_bf16 v102, v59, v19, v102
    v_dot2_f32_bf16 v103, v63, v19, v103
    s_mov_b32 s92, 45056
    buffer_load_dwordx4 v[48:51], v2, s[40:43], s92 offen nt
    s_mov_b32 s92, 45056
    buffer_load_dwordx4 v[52:55], v2, s[40:43], s92 offen offset:1024 nt
    s_mov_b32 s92, 45056
    buffer_load_dwordx4 v[56:59], v2, s[40:43], s92 offen offset:2048 nt
    s_mov_b32 s92, 45056
    buffer_load_dwordx4 v[60:63], v2, s[40:43], s92 offen offset:3072 nt
    v_add_f32_dpp v100, v100, v100 row_ror:8 row_mask:0xf bank_mask:0xf
    v_add_f32_dpp v101, v101, v101 row_ror:8 row_mask:0xf bank_mask:0xf
    v_add_f32_dpp v102, v102, v102 row_ror:8 row_mask:0xf bank_mask:0xf
    v_add_f32_dpp v103, v103, v103 row_ror:8 row_mask:0xf bank_mask:0xf
    v_add_f32_dpp v100, v100, v100 row_ror:4 row_mask:0xf bank_mask:0xf
    v_add_f32_dpp v101, v101, v101 row_ror:4 row_mask:0xf bank_mask:0xf
    v_add_f32_dpp v102, v102, v102 row_ror:4 row_mask:0xf bank_mask:0xf
    v_add_f32_dpp v103, v103, v103 row_ror:4 row_mask:0xf bank_mask:0xf
    v_add_f32_dpp v100, v100, v100 row_ror:2 row_mask:0xf bank_mask:0xf
    v_add_f32_dpp v101, v101, v101 row_ror:2 row_mask:0xf bank_mask:0xf
    v_add_f32_dpp v102, v102, v102 row_ror:2 row_mask:0xf bank_mask:0xf
    v_add_f32_dpp v103, v103, v103 row_ror:2 row_mask:0xf bank_mask:0xf
    v_add_f32_dpp v100, v100, v100 row_ror:1 row_mask:0xf bank_mask:0xf
    v_add_f32_dpp v101, v101, v101 row_ror:1 row_mask:0xf bank_mask:0xf
    v_add_f32_dpp v102, v102, v102 row_ror:1 row_mask:0xf bank_mask:0xf
    v_add_f32_dpp v103, v103, v103 row_ror:1 row_mask:0xf bank_mask:0xf
    v_cvt_pk_bf16_f32 v100, v100, v100
    v_cvt_pk_bf16_f32 v101, v101, v101
    v_cvt_pk_bf16_f32 v102, v102, v102
    v_cvt_pk_bf16_f32 v103, v103, v103
    v_lshlrev_b32 v100, 16, v100
    v_lshlrev_b32 v101, 16, v101
    v_lshlrev_b32 v102, 16, v102
    v_lshlrev_b32 v103, 16, v103
    v_mul_f32 v100, 0x3db504f3, v100
    v_mul_f32 v101, 0x3db504f3, v101
    v_mul_f32 v102, 0x3db504f3, v102
    v_mul_f32 v103, 0x3db504f3, v103
    v_cvt_pk_bf16_f32 v100, v100, v100
    v_cvt_pk_bf16_f32 v101, v101, v101
    v_cvt_pk_bf16_f32 v102, v102, v102
    v_cvt_pk_bf16_f32 v103, v103, v103
    v_lshlrev_b32 v100, 16, v100
    v_lshlrev_b32 v101, 16, v101
    v_lshlrev_b32 v102, 16, v102
    v_lshlrev_b32 v103, 16, v103
    s_waitcnt vmcnt(4)
    v_dot2_f32_bf16 v104, v32, v16, 0
    v_dot2_f32_bf16 v105, v36, v16, 0
    v_dot2_f32_bf16 v106, v40, v16, 0
    v_dot2_f32_bf16 v107, v44, v16, 0
    v_dot2_f32_bf16 v104, v33, v17, v104
    v_dot2_f32_bf16 v105, v37, v17, v105
    v_dot2_f32_bf16 v106, v41, v17, v106
    v_dot2_f32_bf16 v107, v45, v17, v107
    v_dot2_f32_bf16 v104, v34, v18, v104
    v_dot2_f32_bf16 v105, v38, v18, v105
    v_dot2_f32_bf16 v106, v42, v18, v106
    v_dot2_f32_bf16 v107, v46, v18, v107
    v_dot2_f32_bf16 v104, v35, v19, v104
    v_dot2_f32_bf16 v105, v39, v19, v105
    v_dot2_f32_bf16 v106, v43, v19, v106
    v_dot2_f32_bf16 v107, v47, v19, v107
    s_mov_b32 s92, 49152
    buffer_load_dwordx4 v[32:35], v2, s[40:43], s92 offen nt
    s_mov_b32 s92, 49152
    buffer_load_dwordx4 v[36:39], v2, s[40:43], s92 offen offset:1024 nt
    s_mov_b32 s92, 49152
    buffer_load_dwordx4 v[40:43], v2, s[40:43], s92 offen offset:2048 nt
    s_mov_b32 s92, 49152
    buffer_load_dwordx4 v[44:47], v2, s[40:43], s92 offen offset:3072 nt
    v_add_f32_dpp v104, v104, v104 row_ror:8 row_mask:0xf bank_mask:0xf
    v_add_f32_dpp v105, v105, v105 row_ror:8 row_mask:0xf bank_mask:0xf
    v_add_f32_dpp v106, v106, v106 row_ror:8 row_mask:0xf bank_mask:0xf
    v_add_f32_dpp v107, v107, v107 row_ror:8 row_mask:0xf bank_mask:0xf
    v_add_f32_dpp v104, v104, v104 row_ror:4 row_mask:0xf bank_mask:0xf
    v_add_f32_dpp v105, v105, v105 row_ror:4 row_mask:0xf bank_mask:0xf
    v_add_f32_dpp v106, v106, v106 row_ror:4 row_mask:0xf bank_mask:0xf
    v_add_f32_dpp v107, v107, v107 row_ror:4 row_mask:0xf bank_mask:0xf
    v_add_f32_dpp v104, v104, v104 row_ror:2 row_mask:0xf bank_mask:0xf
    v_add_f32_dpp v105, v105, v105 row_ror:2 row_mask:0xf bank_mask:0xf
    v_add_f32_dpp v106, v106, v106 row_ror:2 row_mask:0xf bank_mask:0xf
    v_add_f32_dpp v107, v107, v107 row_ror:2 row_mask:0xf bank_mask:0xf
    v_add_f32_dpp v104, v104, v104 row_ror:1 row_mask:0xf bank_mask:0xf
    v_add_f32_dpp v105, v105, v105 row_ror:1 row_mask:0xf bank_mask:0xf
    v_add_f32_dpp v106, v106, v106 row_ror:1 row_mask:0xf bank_mask:0xf
    v_add_f32_dpp v107, v107, v107 row_ror:1 row_mask:0xf bank_mask:0xf
    v_cvt_pk_bf16_f32 v104, v104, v104
    v_cvt_pk_bf16_f32 v105, v105, v105
    v_cvt_pk_bf16_f32 v106, v106, v106
    v_cvt_pk_bf16_f32 v107, v107, v107
    v_lshlrev_b32 v104, 16, v104
    v_lshlrev_b32 v105, 16, v105
    v_lshlrev_b32 v106, 16, v106
    v_lshlrev_b32 v107, 16, v107
    v_mul_f32 v104, 0x3db504f3, v104
    v_mul_f32 v105, 0x3db504f3, v105
    v_mul_f32 v106, 0x3db504f3, v106
    v_mul_f32 v107, 0x3db504f3, v107
    v_cvt_pk_bf16_f32 v104, v104, v104
    v_cvt_pk_bf16_f32 v105, v105, v105
    v_cvt_pk_bf16_f32 v106, v106, v106
    v_cvt_pk_bf16_f32 v107, v107, v107
    v_lshlrev_b32 v104, 16, v104
    v_lshlrev_b32 v105, 16, v105
    v_lshlrev_b32 v106, 16, v106
    v_lshlrev_b32 v107, 16, v107
    s_waitcnt vmcnt(4)
    v_dot2_f32_bf16 v108, v48, v16, 0
    v_dot2_f32_bf16 v109, v52, v16, 0
    v_dot2_f32_bf16 v110, v56, v16, 0
    v_dot2_f32_bf16 v111, v60, v16, 0
    v_dot2_f32_bf16 v108, v49, v17, v108
    v_dot2_f32_bf16 v109, v53, v17, v109
    v_dot2_f32_bf16 v110, v57, v17, v110
    v_dot2_f32_bf16 v111, v61, v17, v111
    v_dot2_f32_bf16 v108, v50, v18, v108
    v_dot2_f32_bf16 v109, v54, v18, v109
    v_dot2_f32_bf16 v110, v58, v18, v110
    v_dot2_f32_bf16 v111, v62, v18, v111
    v_dot2_f32_bf16 v108, v51, v19, v108
    v_dot2_f32_bf16 v109, v55, v19, v109
    v_dot2_f32_bf16 v110, v59, v19, v110
    v_dot2_f32_bf16 v111, v63, v19, v111
    s_mov_b32 s92, 53248
    buffer_load_dwordx4 v[48:51], v2, s[40:43], s92 offen nt
    s_mov_b32 s92, 53248
    buffer_load_dwordx4 v[52:55], v2, s[40:43], s92 offen offset:1024 nt
    s_mov_b32 s92, 53248
    buffer_load_dwordx4 v[56:59], v2, s[40:43], s92 offen offset:2048 nt
    s_mov_b32 s92, 53248
    buffer_load_dwordx4 v[60:63], v2, s[40:43], s92 offen offset:3072 nt
    v_add_f32_dpp v108, v108, v108 row_ror:8 row_mask:0xf bank_mask:0xf
    v_add_f32_dpp v109, v109, v109 row_ror:8 row_mask:0xf bank_mask:0xf
    v_add_f32_dpp v110, v110, v110 row_ror:8 row_mask:0xf bank_mask:0xf
    v_add_f32_dpp v111, v111, v111 row_ror:8 row_mask:0xf bank_mask:0xf
    v_add_f32_dpp v108, v108, v108 row_ror:4 row_mask:0xf bank_mask:0xf
    v_add_f32_dpp v109, v109, v109 row_ror:4 row_mask:0xf bank_mask:0xf
    v_add_f32_dpp v110, v110, v110 row_ror:4 row_mask:0xf bank_mask:0xf
    v_add_f32_dpp v111, v111, v111 row_ror:4 row_mask:0xf bank_mask:0xf
    v_add_f32_dpp v108, v108, v108 row_ror:2 row_mask:0xf bank_mask:0xf
    v_add_f32_dpp v109, v109, v109 row_ror:2 row_mask:0xf bank_mask:0xf
    v_add_f32_dpp v110, v110, v110 row_ror:2 row_mask:0xf bank_mask:0xf
    v_add_f32_dpp v111, v111, v111 row_ror:2 row_mask:0xf bank_mask:0xf
    v_add_f32_dpp v108, v108, v108 row_ror:1 row_mask:0xf bank_mask:0xf
    v_add_f32_dpp v109, v109, v109 row_ror:1 row_mask:0xf bank_mask:0xf
    v_add_f32_dpp v110, v110, v110 row_ror:1 row_mask:0xf bank_mask:0xf
    v_add_f32_dpp v111, v111, v111 row_ror:1 row_mask:0xf bank_mask:0xf
    v_cvt_pk_bf16_f32 v108, v108, v108
    v_cvt_pk_bf16_f32 v109, v109, v109
    v_cvt_pk_bf16_f32 v110, v110, v110
    v_cvt_pk_bf16_f32 v111, v111, v111
    v_lshlrev_b32 v108, 16, v108
    v_lshlrev_b32 v109, 16, v109
    v_lshlrev_b32 v110, 16, v110
    v_lshlrev_b32 v111, 16, v111
    v_mul_f32 v108, 0x3db504f3, v108
    v_mul_f32 v109, 0x3db504f3, v109
    v_mul_f32 v110, 0x3db504f3, v110
    v_mul_f32 v111, 0x3db504f3, v111
    v_cvt_pk_bf16_f32 v108, v108, v108
    v_cvt_pk_bf16_f32 v109, v109, v109
    v_cvt_pk_bf16_f32 v110, v110, v110
    v_cvt_pk_bf16_f32 v111, v111, v111
    v_lshlrev_b32 v108, 16, v108
    v_lshlrev_b32 v109, 16, v109
    v_lshlrev_b32 v110, 16, v110
    v_lshlrev_b32 v111, 16, v111
    s_waitcnt vmcnt(4)
    v_dot2_f32_bf16 v112, v32, v16, 0
    v_dot2_f32_bf16 v113, v36, v16, 0
    v_dot2_f32_bf16 v114, v40, v16, 0
    v_dot2_f32_bf16 v115, v44, v16, 0
    v_dot2_f32_bf16 v112, v33, v17, v112
    v_dot2_f32_bf16 v113, v37, v17, v113
    v_dot2_f32_bf16 v114, v41, v17, v114
    v_dot2_f32_bf16 v115, v45, v17, v115
    v_dot2_f32_bf16 v112, v34, v18, v112
    v_dot2_f32_bf16 v113, v38, v18, v113
    v_dot2_f32_bf16 v114, v42, v18, v114
    v_dot2_f32_bf16 v115, v46, v18, v115
    v_dot2_f32_bf16 v112, v35, v19, v112
    v_dot2_f32_bf16 v113, v39, v19, v113
    v_dot2_f32_bf16 v114, v43, v19, v114
    v_dot2_f32_bf16 v115, v47, v19, v115
    s_mov_b32 s92, 57344
    buffer_load_dwordx4 v[32:35], v2, s[40:43], s92 offen nt
    s_mov_b32 s92, 57344
    buffer_load_dwordx4 v[36:39], v2, s[40:43], s92 offen offset:1024 nt
    s_mov_b32 s92, 57344
    buffer_load_dwordx4 v[40:43], v2, s[40:43], s92 offen offset:2048 nt
    s_mov_b32 s92, 57344
    buffer_load_dwordx4 v[44:47], v2, s[40:43], s92 offen offset:3072 nt
    v_add_f32_dpp v112, v112, v112 row_ror:8 row_mask:0xf bank_mask:0xf
    v_add_f32_dpp v113, v113, v113 row_ror:8 row_mask:0xf bank_mask:0xf
    v_add_f32_dpp v114, v114, v114 row_ror:8 row_mask:0xf bank_mask:0xf
    v_add_f32_dpp v115, v115, v115 row_ror:8 row_mask:0xf bank_mask:0xf
    v_add_f32_dpp v112, v112, v112 row_ror:4 row_mask:0xf bank_mask:0xf
    v_add_f32_dpp v113, v113, v113 row_ror:4 row_mask:0xf bank_mask:0xf
    v_add_f32_dpp v114, v114, v114 row_ror:4 row_mask:0xf bank_mask:0xf
    v_add_f32_dpp v115, v115, v115 row_ror:4 row_mask:0xf bank_mask:0xf
    v_add_f32_dpp v112, v112, v112 row_ror:2 row_mask:0xf bank_mask:0xf
    v_add_f32_dpp v113, v113, v113 row_ror:2 row_mask:0xf bank_mask:0xf
    v_add_f32_dpp v114, v114, v114 row_ror:2 row_mask:0xf bank_mask:0xf
    v_add_f32_dpp v115, v115, v115 row_ror:2 row_mask:0xf bank_mask:0xf
    v_add_f32_dpp v112, v112, v112 row_ror:1 row_mask:0xf bank_mask:0xf
    v_add_f32_dpp v113, v113, v113 row_ror:1 row_mask:0xf bank_mask:0xf
    v_add_f32_dpp v114, v114, v114 row_ror:1 row_mask:0xf bank_mask:0xf
    v_add_f32_dpp v115, v115, v115 row_ror:1 row_mask:0xf bank_mask:0xf
    v_cvt_pk_bf16_f32 v112, v112, v112
    v_cvt_pk_bf16_f32 v113, v113, v113
    v_cvt_pk_bf16_f32 v114, v114, v114
    v_cvt_pk_bf16_f32 v115, v115, v115
    v_lshlrev_b32 v112, 16, v112
    v_lshlrev_b32 v113, 16, v113
    v_lshlrev_b32 v114, 16, v114
    v_lshlrev_b32 v115, 16, v115
    v_mul_f32 v112, 0x3db504f3, v112
    v_mul_f32 v113, 0x3db504f3, v113
    v_mul_f32 v114, 0x3db504f3, v114
    v_mul_f32 v115, 0x3db504f3, v115
    v_cvt_pk_bf16_f32 v112, v112, v112
    v_cvt_pk_bf16_f32 v113, v113, v113
    v_cvt_pk_bf16_f32 v114, v114, v114
    v_cvt_pk_bf16_f32 v115, v115, v115
    v_lshlrev_b32 v112, 16, v112
    v_lshlrev_b32 v113, 16, v113
    v_lshlrev_b32 v114, 16, v114
    v_lshlrev_b32 v115, 16, v115
    s_waitcnt vmcnt(4)
    v_dot2_f32_bf16 v116, v48, v16, 0
    v_dot2_f32_bf16 v117, v52, v16, 0
    v_dot2_f32_bf16 v118, v56, v16, 0
    v_dot2_f32_bf16 v119, v60, v16, 0
    v_dot2_f32_bf16 v116, v49, v17, v116
    v_dot2_f32_bf16 v117, v53, v17, v117
    v_dot2_f32_bf16 v118, v57, v17, v118
    v_dot2_f32_bf16 v119, v61, v17, v119
    v_dot2_f32_bf16 v116, v50, v18, v116
    v_dot2_f32_bf16 v117, v54, v18, v117
    v_dot2_f32_bf16 v118, v58, v18, v118
    v_dot2_f32_bf16 v119, v62, v18, v119
    v_dot2_f32_bf16 v116, v51, v19, v116
    v_dot2_f32_bf16 v117, v55, v19, v117
    v_dot2_f32_bf16 v118, v59, v19, v118
    v_dot2_f32_bf16 v119, v63, v19, v119
    s_mov_b32 s92, 61440
    buffer_load_dwordx4 v[48:51], v2, s[40:43], s92 offen nt
    s_mov_b32 s92, 61440
    buffer_load_dwordx4 v[52:55], v2, s[40:43], s92 offen offset:1024 nt
    s_mov_b32 s92, 61440
    buffer_load_dwordx4 v[56:59], v2, s[40:43], s92 offen offset:2048 nt
    s_mov_b32 s92, 61440
    buffer_load_dwordx4 v[60:63], v2, s[40:43], s92 offen offset:3072 nt
    v_add_f32_dpp v116, v116, v116 row_ror:8 row_mask:0xf bank_mask:0xf
    v_add_f32_dpp v117, v117, v117 row_ror:8 row_mask:0xf bank_mask:0xf
    v_add_f32_dpp v118, v118, v118 row_ror:8 row_mask:0xf bank_mask:0xf
    v_add_f32_dpp v119, v119, v119 row_ror:8 row_mask:0xf bank_mask:0xf
    v_add_f32_dpp v116, v116, v116 row_ror:4 row_mask:0xf bank_mask:0xf
    v_add_f32_dpp v117, v117, v117 row_ror:4 row_mask:0xf bank_mask:0xf
    v_add_f32_dpp v118, v118, v118 row_ror:4 row_mask:0xf bank_mask:0xf
    v_add_f32_dpp v119, v119, v119 row_ror:4 row_mask:0xf bank_mask:0xf
    v_add_f32_dpp v116, v116, v116 row_ror:2 row_mask:0xf bank_mask:0xf
    v_add_f32_dpp v117, v117, v117 row_ror:2 row_mask:0xf bank_mask:0xf
    v_add_f32_dpp v118, v118, v118 row_ror:2 row_mask:0xf bank_mask:0xf
    v_add_f32_dpp v119, v119, v119 row_ror:2 row_mask:0xf bank_mask:0xf
    v_add_f32_dpp v116, v116, v116 row_ror:1 row_mask:0xf bank_mask:0xf
    v_add_f32_dpp v117, v117, v117 row_ror:1 row_mask:0xf bank_mask:0xf
    v_add_f32_dpp v118, v118, v118 row_ror:1 row_mask:0xf bank_mask:0xf
    v_add_f32_dpp v119, v119, v119 row_ror:1 row_mask:0xf bank_mask:0xf
    v_cvt_pk_bf16_f32 v116, v116, v116
    v_cvt_pk_bf16_f32 v117, v117, v117
    v_cvt_pk_bf16_f32 v118, v118, v118
    v_cvt_pk_bf16_f32 v119, v119, v119
    v_lshlrev_b32 v116, 16, v116
    v_lshlrev_b32 v117, 16, v117
    v_lshlrev_b32 v118, 16, v118
    v_lshlrev_b32 v119, 16, v119
    v_mul_f32 v116, 0x3db504f3, v116
    v_mul_f32 v117, 0x3db504f3, v117
    v_mul_f32 v118, 0x3db504f3, v118
    v_mul_f32 v119, 0x3db504f3, v119
    v_cvt_pk_bf16_f32 v116, v116, v116
    v_cvt_pk_bf16_f32 v117, v117, v117
    v_cvt_pk_bf16_f32 v118, v118, v118
    v_cvt_pk_bf16_f32 v119, v119, v119
    v_lshlrev_b32 v116, 16, v116
    v_lshlrev_b32 v117, 16, v117
    v_lshlrev_b32 v118, 16, v118
    v_lshlrev_b32 v119, 16, v119
    s_waitcnt vmcnt(4)
    v_dot2_f32_bf16 v120, v32, v16, 0
    v_dot2_f32_bf16 v121, v36, v16, 0
    v_dot2_f32_bf16 v122, v40, v16, 0
    v_dot2_f32_bf16 v123, v44, v16, 0
    v_dot2_f32_bf16 v120, v33, v17, v120
    v_dot2_f32_bf16 v121, v37, v17, v121
    v_dot2_f32_bf16 v122, v41, v17, v122
    v_dot2_f32_bf16 v123, v45, v17, v123
    v_dot2_f32_bf16 v120, v34, v18, v120
    v_dot2_f32_bf16 v121, v38, v18, v121
    v_dot2_f32_bf16 v122, v42, v18, v122
    v_dot2_f32_bf16 v123, v46, v18, v123
    v_dot2_f32_bf16 v120, v35, v19, v120
    v_dot2_f32_bf16 v121, v39, v19, v121
    v_dot2_f32_bf16 v122, v43, v19, v122
    v_dot2_f32_bf16 v123, v47, v19, v123
    s_mov_b32 s92, 0
    buffer_load_dwordx4 v[32:35], v13, s[56:59], s92 offen
    s_mov_b32 s92, 352256
    buffer_load_dwordx4 v[36:39], v13, s[56:59], s92 offen
    s_mov_b32 s92, 704512
    buffer_load_dwordx4 v[40:43], v13, s[56:59], s92 offen
    s_mov_b32 s92, 1056768
    buffer_load_dwordx4 v[44:47], v13, s[56:59], s92 offen
    v_add_f32_dpp v120, v120, v120 row_ror:8 row_mask:0xf bank_mask:0xf
    v_add_f32_dpp v121, v121, v121 row_ror:8 row_mask:0xf bank_mask:0xf
    v_add_f32_dpp v122, v122, v122 row_ror:8 row_mask:0xf bank_mask:0xf
    v_add_f32_dpp v123, v123, v123 row_ror:8 row_mask:0xf bank_mask:0xf
    v_add_f32_dpp v120, v120, v120 row_ror:4 row_mask:0xf bank_mask:0xf
    v_add_f32_dpp v121, v121, v121 row_ror:4 row_mask:0xf bank_mask:0xf
    v_add_f32_dpp v122, v122, v122 row_ror:4 row_mask:0xf bank_mask:0xf
    v_add_f32_dpp v123, v123, v123 row_ror:4 row_mask:0xf bank_mask:0xf
    v_add_f32_dpp v120, v120, v120 row_ror:2 row_mask:0xf bank_mask:0xf
    v_add_f32_dpp v121, v121, v121 row_ror:2 row_mask:0xf bank_mask:0xf
    v_add_f32_dpp v122, v122, v122 row_ror:2 row_mask:0xf bank_mask:0xf
    v_add_f32_dpp v123, v123, v123 row_ror:2 row_mask:0xf bank_mask:0xf
    v_add_f32_dpp v120, v120, v120 row_ror:1 row_mask:0xf bank_mask:0xf
    v_add_f32_dpp v121, v121, v121 row_ror:1 row_mask:0xf bank_mask:0xf
    v_add_f32_dpp v122, v122, v122 row_ror:1 row_mask:0xf bank_mask:0xf
    v_add_f32_dpp v123, v123, v123 row_ror:1 row_mask:0xf bank_mask:0xf
    v_cvt_pk_bf16_f32 v120, v120, v120
    v_cvt_pk_bf16_f32 v121, v121, v121
    v_cvt_pk_bf16_f32 v122, v122, v122
    v_cvt_pk_bf16_f32 v123, v123, v123
    v_lshlrev_b32 v120, 16, v120
    v_lshlrev_b32 v121, 16, v121
    v_lshlrev_b32 v122, 16, v122
    v_lshlrev_b32 v123, 16, v123
    v_mul_f32 v120, 0x3db504f3, v120
    v_mul_f32 v121, 0x3db504f3, v121
    v_mul_f32 v122, 0x3db504f3, v122
    v_mul_f32 v123, 0x3db504f3, v123
    v_cvt_pk_bf16_f32 v120, v120, v120
    v_cvt_pk_bf16_f32 v121, v121, v121
    v_cvt_pk_bf16_f32 v122, v122, v122
    v_cvt_pk_bf16_f32 v123, v123, v123
    v_lshlrev_b32 v120, 16, v120
    v_lshlrev_b32 v121, 16, v121
    v_lshlrev_b32 v122, 16, v122
    v_lshlrev_b32 v123, 16, v123
    s_waitcnt vmcnt(4)
    v_dot2_f32_bf16 v124, v48, v16, 0
    v_dot2_f32_bf16 v125, v52, v16, 0
    v_dot2_f32_bf16 v126, v56, v16, 0
    v_dot2_f32_bf16 v127, v60, v16, 0
    v_dot2_f32_bf16 v124, v49, v17, v124
    v_dot2_f32_bf16 v125, v53, v17, v125
    v_dot2_f32_bf16 v126, v57, v17, v126
    v_dot2_f32_bf16 v127, v61, v17, v127
    v_dot2_f32_bf16 v124, v50, v18, v124
    v_dot2_f32_bf16 v125, v54, v18, v125
    v_dot2_f32_bf16 v126, v58, v18, v126
    v_dot2_f32_bf16 v127, v62, v18, v127
    v_dot2_f32_bf16 v124, v51, v19, v124
    v_dot2_f32_bf16 v125, v55, v19, v125
    v_dot2_f32_bf16 v126, v59, v19, v126
    v_dot2_f32_bf16 v127, v63, v19, v127
    s_mov_b32 s92, 0
    buffer_load_dwordx4 v[48:51], v13, s[60:63], s92 offen
    s_mov_b32 s92, 352256
    buffer_load_dwordx4 v[52:55], v13, s[60:63], s92 offen
    s_mov_b32 s92, 704512
    buffer_load_dwordx4 v[56:59], v13, s[60:63], s92 offen
    s_mov_b32 s92, 1056768
    buffer_load_dwordx4 v[60:63], v13, s[60:63], s92 offen
    v_add_f32_dpp v124, v124, v124 row_ror:8 row_mask:0xf bank_mask:0xf
    v_add_f32_dpp v125, v125, v125 row_ror:8 row_mask:0xf bank_mask:0xf
    v_add_f32_dpp v126, v126, v126 row_ror:8 row_mask:0xf bank_mask:0xf
    v_add_f32_dpp v127, v127, v127 row_ror:8 row_mask:0xf bank_mask:0xf
    v_add_f32_dpp v124, v124, v124 row_ror:4 row_mask:0xf bank_mask:0xf
    v_add_f32_dpp v125, v125, v125 row_ror:4 row_mask:0xf bank_mask:0xf
    v_add_f32_dpp v126, v126, v126 row_ror:4 row_mask:0xf bank_mask:0xf
    v_add_f32_dpp v127, v127, v127 row_ror:4 row_mask:0xf bank_mask:0xf
    v_add_f32_dpp v124, v124, v124 row_ror:2 row_mask:0xf bank_mask:0xf
    v_add_f32_dpp v125, v125, v125 row_ror:2 row_mask:0xf bank_mask:0xf
    v_add_f32_dpp v126, v126, v126 row_ror:2 row_mask:0xf bank_mask:0xf
    v_add_f32_dpp v127, v127, v127 row_ror:2 row_mask:0xf bank_mask:0xf
    v_add_f32_dpp v124, v124, v124 row_ror:1 row_mask:0xf bank_mask:0xf
    v_add_f32_dpp v125, v125, v125 row_ror:1 row_mask:0xf bank_mask:0xf
    v_add_f32_dpp v126, v126, v126 row_ror:1 row_mask:0xf bank_mask:0xf
    v_add_f32_dpp v127, v127, v127 row_ror:1 row_mask:0xf bank_mask:0xf
    v_cvt_pk_bf16_f32 v124, v124, v124
    v_cvt_pk_bf16_f32 v125, v125, v125
    v_cvt_pk_bf16_f32 v126, v126, v126
    v_cvt_pk_bf16_f32 v127, v127, v127
    v_lshlrev_b32 v124, 16, v124
    v_lshlrev_b32 v125, 16, v125
    v_lshlrev_b32 v126, 16, v126
    v_lshlrev_b32 v127, 16, v127
    v_mul_f32 v124, 0x3db504f3, v124
    v_mul_f32 v125, 0x3db504f3, v125
    v_mul_f32 v126, 0x3db504f3, v126
    v_mul_f32 v127, 0x3db504f3, v127
    v_cvt_pk_bf16_f32 v124, v124, v124
    v_cvt_pk_bf16_f32 v125, v125, v125
    v_cvt_pk_bf16_f32 v126, v126, v126
    v_cvt_pk_bf16_f32 v127, v127, v127
    v_lshlrev_b32 v124, 16, v124
    v_lshlrev_b32 v125, 16, v125
    v_lshlrev_b32 v126, 16, v126
    v_lshlrev_b32 v127, 16, v127
    v_lshrrev_b32 v4, 3, v1
    s_lshl_b32 s7, s6, 3
    v_add_u32 v4, s7, v4
    v_lshlrev_b32 v3, 2, v4
    ds_read_b32 v8, v3 offset:0
    ds_read_b32 v9, v3 offset:512
    ds_read_b32 v10, v3 offset:1024
    ds_read_b32 v11, v3 offset:1536
    s_lshl_b32 s7, s6, 9
    s_add_u32 s7, s7, 36864
    v_and_b32 v5, 7, v1
    v_lshlrev_b32 v6, 5, v5
    v_add_u32 v6, s7, v6
    s_waitcnt lgkmcnt(0)
    v_mov_b32 v20, 0
    v_mov_b32 v21, 0
    v_mov_b32 v22, 0
    v_mov_b32 v23, 0
    v_mov_b32 v24, 0
    v_mov_b32 v25, 0
    v_mov_b32 v26, 0
    v_mov_b32 v27, 0
    s_waitcnt vmcnt(7)
    v_lshlrev_b32 v4, 16, v32
    v_and_b32 v5, 0xffff0000, v32
    v_fmac_f32 v20, v8, v4
    v_fmac_f32 v21, v8, v5
    v_lshlrev_b32 v4, 16, v33
    v_and_b32 v5, 0xffff0000, v33
    v_fmac_f32 v22, v8, v4
    v_fmac_f32 v23, v8, v5
    v_lshlrev_b32 v4, 16, v34
    v_and_b32 v5, 0xffff0000, v34
    v_fmac_f32 v24, v8, v4
    v_fmac_f32 v25, v8, v5
    v_lshlrev_b32 v4, 16, v35
    v_and_b32 v5, 0xffff0000, v35
    v_fmac_f32 v26, v8, v4
    v_fmac_f32 v27, v8, v5
    buffer_load_dwordx4 v[32:35], v2, s[44:47], 0 offen nt
    s_waitcnt vmcnt(7)
    v_lshlrev_b32 v4, 16, v36
    v_and_b32 v5, 0xffff0000, v36
    v_fmac_f32 v20, v9, v4
    v_fmac_f32 v21, v9, v5
    v_lshlrev_b32 v4, 16, v37
    v_and_b32 v5, 0xffff0000, v37
    v_fmac_f32 v22, v9, v4
    v_fmac_f32 v23, v9, v5
    v_lshlrev_b32 v4, 16, v38
    v_and_b32 v5, 0xffff0000, v38
    v_fmac_f32 v24, v9, v4
    v_fmac_f32 v25, v9, v5
    v_lshlrev_b32 v4, 16, v39
    v_and_b32 v5, 0xffff0000, v39
    v_fmac_f32 v26, v9, v4
    v_fmac_f32 v27, v9, v5
    buffer_load_dwordx4 v[36:39], v2, s[44:47], 0 offen offset:1024 nt
    s_waitcnt vmcnt(7)
    v_lshlrev_b32 v4, 16, v40
    v_and_b32 v5, 0xffff0000, v40
    v_fmac_f32 v20, v10, v4
    v_fmac_f32 v21, v10, v5
    v_lshlrev_b32 v4, 16, v41
    v_and_b32 v5, 0xffff0000, v41
    v_fmac_f32 v22, v10, v4
    v_fmac_f32 v23, v10, v5
    v_lshlrev_b32 v4, 16, v42
    v_and_b32 v5, 0xffff0000, v42
    v_fmac_f32 v24, v10, v4
    v_fmac_f32 v25, v10, v5
    v_lshlrev_b32 v4, 16, v43
    v_and_b32 v5, 0xffff0000, v43
    v_fmac_f32 v26, v10, v4
    v_fmac_f32 v27, v10, v5
    buffer_load_dwordx4 v[40:43], v2, s[44:47], 0 offen offset:2048 nt
    s_waitcnt vmcnt(7)
    v_lshlrev_b32 v4, 16, v44
    v_and_b32 v5, 0xffff0000, v44
    v_fmac_f32 v20, v11, v4
    v_fmac_f32 v21, v11, v5
    v_lshlrev_b32 v4, 16, v45
    v_and_b32 v5, 0xffff0000, v45
    v_fmac_f32 v22, v11, v4
    v_fmac_f32 v23, v11, v5
    v_lshlrev_b32 v4, 16, v46
    v_and_b32 v5, 0xffff0000, v46
    v_fmac_f32 v24, v11, v4
    v_fmac_f32 v25, v11, v5
    v_lshlrev_b32 v4, 16, v47
    v_and_b32 v5, 0xffff0000, v47
    v_fmac_f32 v26, v11, v4
    v_fmac_f32 v27, v11, v5
    buffer_load_dwordx4 v[44:47], v2, s[44:47], 0 offen offset:3072 nt
    s_nop 1
    v_add_f32_dpp v20, v20, v20 row_ror:8 row_mask:0xf bank_mask:0xf
    v_add_f32_dpp v21, v21, v21 row_ror:8 row_mask:0xf bank_mask:0xf
    v_add_f32_dpp v22, v22, v22 row_ror:8 row_mask:0xf bank_mask:0xf
    v_add_f32_dpp v23, v23, v23 row_ror:8 row_mask:0xf bank_mask:0xf
    v_add_f32_dpp v24, v24, v24 row_ror:8 row_mask:0xf bank_mask:0xf
    v_add_f32_dpp v25, v25, v25 row_ror:8 row_mask:0xf bank_mask:0xf
    v_add_f32_dpp v26, v26, v26 row_ror:8 row_mask:0xf bank_mask:0xf
    v_add_f32_dpp v27, v27, v27 row_ror:8 row_mask:0xf bank_mask:0xf
    v_mov_b32 v4, v20
    v_mov_b32 v5, v21
    v_mov_b32 v12, v22
    v_mov_b32 v14, v23
    s_nop 1
    v_permlane16_swap_b32 v20, v4
    v_permlane16_swap_b32 v21, v5
    v_permlane16_swap_b32 v22, v12
    v_permlane16_swap_b32 v23, v14
    s_nop 1
    v_add_f32 v20, v20, v4
    v_add_f32 v21, v21, v5
    v_add_f32 v22, v22, v12
    v_add_f32 v23, v23, v14
    v_mov_b32 v4, v24
    v_mov_b32 v5, v25
    v_mov_b32 v12, v26
    v_mov_b32 v14, v27
    s_nop 1
    v_permlane16_swap_b32 v24, v4
    v_permlane16_swap_b32 v25, v5
    v_permlane16_swap_b32 v26, v12
    v_permlane16_swap_b32 v27, v14
    s_nop 1
    v_add_f32 v24, v24, v4
    v_add_f32 v25, v25, v5
    v_add_f32 v26, v26, v12
    v_add_f32 v27, v27, v14
    v_mov_b32 v4, v20
    v_mov_b32 v5, v21
    v_mov_b32 v12, v22
    v_mov_b32 v14, v23
    s_nop 1
    v_permlane32_swap_b32 v20, v4
    v_permlane32_swap_b32 v21, v5
    v_permlane32_swap_b32 v22, v12
    v_permlane32_swap_b32 v23, v14
    s_nop 1
    v_add_f32 v20, v20, v4
    v_add_f32 v21, v21, v5
    v_add_f32 v22, v22, v12
    v_add_f32 v23, v23, v14
    v_mov_b32 v4, v24
    v_mov_b32 v5, v25
    v_mov_b32 v12, v26
    v_mov_b32 v14, v27
    s_nop 1
    v_permlane32_swap_b32 v24, v4
    v_permlane32_swap_b32 v25, v5
    v_permlane32_swap_b32 v26, v12
    v_permlane32_swap_b32 v27, v14
    s_nop 1
    v_add_f32 v24, v24, v4
    v_add_f32 v25, v25, v5
    v_add_f32 v26, v26, v12
    v_add_f32 v27, v27, v14
    s_mov_b64 s[10:11], exec
    s_mov_b64 exec, 0xff
    ds_write_b128 v6, v[20:23] offset:0
    ds_write_b128 v6, v[24:27] offset:16
    s_mov_b64 exec, s[10:11]
    s_waitcnt lgkmcnt(0)
    v_mov_b32 v20, 0
    v_mov_b32 v21, 0
    v_mov_b32 v22, 0
    v_mov_b32 v23, 0
    v_mov_b32 v24, 0
    v_mov_b32 v25, 0
    v_mov_b32 v26, 0
    v_mov_b32 v27, 0
    s_waitcnt vmcnt(7)
    v_lshlrev_b32 v4, 16, v48
    v_and_b32 v5, 0xffff0000, v48
    v_fmac_f32 v20, v8, v4
    v_fmac_f32 v21, v8, v5
    v_lshlrev_b32 v4, 16, v49
    v_and_b32 v5, 0xffff0000, v49
    v_fmac_f32 v22, v8, v4
    v_fmac_f32 v23, v8, v5
    v_lshlrev_b32 v4, 16, v50
    v_and_b32 v5, 0xffff0000, v50
    v_fmac_f32 v24, v8, v4
    v_fmac_f32 v25, v8, v5
    v_lshlrev_b32 v4, 16, v51
    v_and_b32 v5, 0xffff0000, v51
    v_fmac_f32 v26, v8, v4
    v_fmac_f32 v27, v8, v5
    s_mov_b32 s92, 4096
    buffer_load_dwordx4 v[48:51], v2, s[44:47], s92 offen nt
    s_waitcnt vmcnt(7)
    v_lshlrev_b32 v4, 16, v52
    v_and_b32 v5, 0xffff0000, v52
    v_fmac_f32 v20, v9, v4
    v_fmac_f32 v21, v9, v5
    v_lshlrev_b32 v4, 16, v53
    v_and_b32 v5, 0xffff0000, v53
    v_fmac_f32 v22, v9, v4
    v_fmac_f32 v23, v9, v5
    v_lshlrev_b32 v4, 16, v54
    v_and_b32 v5, 0xffff0000, v54
    v_fmac_f32 v24, v9, v4
    v_fmac_f32 v25, v9, v5
    v_lshlrev_b32 v4, 16, v55
    v_and_b32 v5, 0xffff0000, v55
    v_fmac_f32 v26, v9, v4
    v_fmac_f32 v27, v9, v5
    s_mov_b32 s92, 4096
    buffer_load_dwordx4 v[52:55], v2, s[44:47], s92 offen offset:1024 nt
    s_waitcnt vmcnt(7)
    v_lshlrev_b32 v4, 16, v56
    v_and_b32 v5, 0xffff0000, v56
    v_fmac_f32 v20, v10, v4
    v_fmac_f32 v21, v10, v5
    v_lshlrev_b32 v4, 16, v57
    v_and_b32 v5, 0xffff0000, v57
    v_fmac_f32 v22, v10, v4
    v_fmac_f32 v23, v10, v5
    v_lshlrev_b32 v4, 16, v58
    v_and_b32 v5, 0xffff0000, v58
    v_fmac_f32 v24, v10, v4
    v_fmac_f32 v25, v10, v5
    v_lshlrev_b32 v4, 16, v59
    v_and_b32 v5, 0xffff0000, v59
    v_fmac_f32 v26, v10, v4
    v_fmac_f32 v27, v10, v5
    s_mov_b32 s92, 4096
    buffer_load_dwordx4 v[56:59], v2, s[44:47], s92 offen offset:2048 nt
    s_waitcnt vmcnt(7)
    v_lshlrev_b32 v4, 16, v60
    v_and_b32 v5, 0xffff0000, v60
    v_fmac_f32 v20, v11, v4
    v_fmac_f32 v21, v11, v5
    v_lshlrev_b32 v4, 16, v61
    v_and_b32 v5, 0xffff0000, v61
    v_fmac_f32 v22, v11, v4
    v_fmac_f32 v23, v11, v5
    v_lshlrev_b32 v4, 16, v62
    v_and_b32 v5, 0xffff0000, v62
    v_fmac_f32 v24, v11, v4
    v_fmac_f32 v25, v11, v5
    v_lshlrev_b32 v4, 16, v63
    v_and_b32 v5, 0xffff0000, v63
    v_fmac_f32 v26, v11, v4
    v_fmac_f32 v27, v11, v5
    s_mov_b32 s92, 4096
    buffer_load_dwordx4 v[60:63], v2, s[44:47], s92 offen offset:3072 nt
    s_nop 1
    v_add_f32_dpp v20, v20, v20 row_ror:8 row_mask:0xf bank_mask:0xf
    v_add_f32_dpp v21, v21, v21 row_ror:8 row_mask:0xf bank_mask:0xf
    v_add_f32_dpp v22, v22, v22 row_ror:8 row_mask:0xf bank_mask:0xf
    v_add_f32_dpp v23, v23, v23 row_ror:8 row_mask:0xf bank_mask:0xf
    v_add_f32_dpp v24, v24, v24 row_ror:8 row_mask:0xf bank_mask:0xf
    v_add_f32_dpp v25, v25, v25 row_ror:8 row_mask:0xf bank_mask:0xf
    v_add_f32_dpp v26, v26, v26 row_ror:8 row_mask:0xf bank_mask:0xf
    v_add_f32_dpp v27, v27, v27 row_ror:8 row_mask:0xf bank_mask:0xf
    v_mov_b32 v4, v20
    v_mov_b32 v5, v21
    v_mov_b32 v12, v22
    v_mov_b32 v14, v23
    s_nop 1
    v_permlane16_swap_b32 v20, v4
    v_permlane16_swap_b32 v21, v5
    v_permlane16_swap_b32 v22, v12
    v_permlane16_swap_b32 v23, v14
    s_nop 1
    v_add_f32 v20, v20, v4
    v_add_f32 v21, v21, v5
    v_add_f32 v22, v22, v12
    v_add_f32 v23, v23, v14
    v_mov_b32 v4, v24
    v_mov_b32 v5, v25
    v_mov_b32 v12, v26
    v_mov_b32 v14, v27
    s_nop 1
    v_permlane16_swap_b32 v24, v4
    v_permlane16_swap_b32 v25, v5
    v_permlane16_swap_b32 v26, v12
    v_permlane16_swap_b32 v27, v14
    s_nop 1
    v_add_f32 v24, v24, v4
    v_add_f32 v25, v25, v5
    v_add_f32 v26, v26, v12
    v_add_f32 v27, v27, v14
    v_mov_b32 v4, v20
    v_mov_b32 v5, v21
    v_mov_b32 v12, v22
    v_mov_b32 v14, v23
    s_nop 1
    v_permlane32_swap_b32 v20, v4
    v_permlane32_swap_b32 v21, v5
    v_permlane32_swap_b32 v22, v12
    v_permlane32_swap_b32 v23, v14
    s_nop 1
    v_add_f32 v20, v20, v4
    v_add_f32 v21, v21, v5
    v_add_f32 v22, v22, v12
    v_add_f32 v23, v23, v14
    v_mov_b32 v4, v24
    v_mov_b32 v5, v25
    v_mov_b32 v12, v26
    v_mov_b32 v14, v27
    s_nop 1
    v_permlane32_swap_b32 v24, v4
    v_permlane32_swap_b32 v25, v5
    v_permlane32_swap_b32 v26, v12
    v_permlane32_swap_b32 v27, v14
    s_nop 1
    v_add_f32 v24, v24, v4
    v_add_f32 v25, v25, v5
    v_add_f32 v26, v26, v12
    v_add_f32 v27, v27, v14
    s_mov_b64 s[10:11], exec
    s_mov_b64 exec, 0xff
    ds_write_b128 v6, v[20:23] offset:256
    ds_write_b128 v6, v[24:27] offset:272
    s_mov_b64 exec, s[10:11]
    s_waitcnt lgkmcnt(0)
    v_max3_f32 v28, v64, v65, v66
    v_max3_f32 v28, v28, v67, v68
    v_max3_f32 v28, v28, v69, v70
    v_max3_f32 v28, v28, v71, v72
    v_max3_f32 v28, v28, v73, v74
    v_max3_f32 v28, v28, v75, v76
    v_max3_f32 v28, v28, v77, v78
    v_max3_f32 v28, v28, v79, v80
    v_max3_f32 v28, v28, v81, v82
    v_max3_f32 v28, v28, v83, v84
    v_max3_f32 v28, v28, v85, v86
    v_max3_f32 v28, v28, v87, v88
    v_max3_f32 v28, v28, v89, v90
    v_max3_f32 v28, v28, v91, v92
    v_max3_f32 v28, v28, v93, v94
    v_max3_f32 v28, v28, v95, v96
    v_max3_f32 v28, v28, v97, v98
    v_max3_f32 v28, v28, v99, v100
    v_max3_f32 v28, v28, v101, v102
    v_max3_f32 v28, v28, v103, v104
    v_max3_f32 v28, v28, v105, v106
    v_max3_f32 v28, v28, v107, v108
    v_max3_f32 v28, v28, v109, v110
    v_max3_f32 v28, v28, v111, v112
    v_max3_f32 v28, v28, v113, v114
    v_max3_f32 v28, v28, v115, v116
    v_max3_f32 v28, v28, v117, v118
    v_max3_f32 v28, v28, v119, v120
    v_max3_f32 v28, v28, v121, v122
    v_max3_f32 v28, v28, v123, v124
    v_max3_f32 v28, v28, v125, v126
    v_max_f32 v28, v28, v127
    v_mul_f32 v29, 0x3fb8aa3b, v28
    v_mov_b32 v30, 0
    s_mov_b32 s7, 0x3fb8aa3b
    v_fma_f32 v64, v64, s7, -v29
    v_fma_f32 v65, v65, s7, -v29
    v_fma_f32 v66, v66, s7, -v29
    v_fma_f32 v67, v67, s7, -v29
    v_fma_f32 v68, v68, s7, -v29
    v_fma_f32 v69, v69, s7, -v29
    v_fma_f32 v70, v70, s7, -v29
    v_fma_f32 v71, v71, s7, -v29
    v_fma_f32 v72, v72, s7, -v29
    v_fma_f32 v73, v73, s7, -v29
    v_fma_f32 v74, v74, s7, -v29
    v_fma_f32 v75, v75, s7, -v29
    v_fma_f32 v76, v76, s7, -v29
    v_fma_f32 v77, v77, s7, -v29
    v_fma_f32 v78, v78, s7, -v29
    v_fma_f32 v79, v79, s7, -v29
    v_fma_f32 v80, v80, s7, -v29
    v_fma_f32 v81, v81, s7, -v29
    v_fma_f32 v82, v82, s7, -v29
    v_fma_f32 v83, v83, s7, -v29
    v_fma_f32 v84, v84, s7, -v29
    v_fma_f32 v85, v85, s7, -v29
    v_fma_f32 v86, v86, s7, -v29
    v_fma_f32 v87, v87, s7, -v29
    v_fma_f32 v88, v88, s7, -v29
    v_fma_f32 v89, v89, s7, -v29
    v_fma_f32 v90, v90, s7, -v29
    v_fma_f32 v91, v91, s7, -v29
    v_fma_f32 v92, v92, s7, -v29
    v_fma_f32 v93, v93, s7, -v29
    v_fma_f32 v94, v94, s7, -v29
    v_fma_f32 v95, v95, s7, -v29
    v_fma_f32 v96, v96, s7, -v29
    v_fma_f32 v97, v97, s7, -v29
    v_fma_f32 v98, v98, s7, -v29
    v_fma_f32 v99, v99, s7, -v29
    v_fma_f32 v100, v100, s7, -v29
    v_fma_f32 v101, v101, s7, -v29
    v_fma_f32 v102, v102, s7, -v29
    v_fma_f32 v103, v103, s7, -v29
    v_fma_f32 v104, v104, s7, -v29
    v_fma_f32 v105, v105, s7, -v29
    v_fma_f32 v106, v106, s7, -v29
    v_fma_f32 v107, v107, s7, -v29
    v_fma_f32 v108, v108, s7, -v29
    v_fma_f32 v109, v109, s7, -v29
    v_fma_f32 v110, v110, s7, -v29
    v_fma_f32 v111, v111, s7, -v29
    v_fma_f32 v112, v112, s7, -v29
    v_fma_f32 v113, v113, s7, -v29
    v_fma_f32 v114, v114, s7, -v29
    v_fma_f32 v115, v115, s7, -v29
    v_fma_f32 v116, v116, s7, -v29
    v_fma_f32 v117, v117, s7, -v29
    v_fma_f32 v118, v118, s7, -v29
    v_fma_f32 v119, v119, s7, -v29
    v_fma_f32 v120, v120, s7, -v29
    v_fma_f32 v121, v121, s7, -v29
    v_fma_f32 v122, v122, s7, -v29
    v_fma_f32 v123, v123, s7, -v29
    v_fma_f32 v124, v124, s7, -v29
    v_fma_f32 v125, v125, s7, -v29
    v_fma_f32 v126, v126, s7, -v29
    v_fma_f32 v127, v127, s7, -v29
    v_exp_f32 v64, v64
    v_exp_f32 v65, v65
    v_exp_f32 v66, v66
    v_exp_f32 v67, v67
    v_exp_f32 v68, v68
    v_exp_f32 v69, v69
    v_exp_f32 v70, v70
    v_exp_f32 v71, v71
    v_exp_f32 v72, v72
    v_exp_f32 v73, v73
    v_exp_f32 v74, v74
    v_exp_f32 v75, v75
    v_exp_f32 v76, v76
    v_exp_f32 v77, v77
    v_exp_f32 v78, v78
    v_exp_f32 v79, v79
    v_exp_f32 v80, v80
    v_exp_f32 v81, v81
    v_exp_f32 v82, v82
    v_exp_f32 v83, v83
    v_exp_f32 v84, v84
    v_exp_f32 v85, v85
    v_exp_f32 v86, v86
    v_exp_f32 v87, v87
    v_exp_f32 v88, v88
    v_exp_f32 v89, v89
    v_exp_f32 v90, v90
    v_exp_f32 v91, v91
    v_exp_f32 v92, v92
    v_exp_f32 v93, v93
    v_exp_f32 v94, v94
    v_exp_f32 v95, v95
    v_exp_f32 v96, v96
    v_exp_f32 v97, v97
    v_exp_f32 v98, v98
    v_exp_f32 v99, v99
    v_exp_f32 v100, v100
    v_exp_f32 v101, v101
    v_exp_f32 v102, v102
    v_exp_f32 v103, v103
    v_exp_f32 v104, v104
    v_exp_f32 v105, v105
    v_exp_f32 v106, v106
    v_exp_f32 v107, v107
    v_exp_f32 v108, v108
    v_exp_f32 v109, v109
    v_exp_f32 v110, v110
    v_exp_f32 v111, v111
    v_exp_f32 v112, v112
    v_exp_f32 v113, v113
    v_exp_f32 v114, v114
    v_exp_f32 v115, v115
    v_exp_f32 v116, v116
    v_exp_f32 v117, v117
    v_exp_f32 v118, v118
    v_exp_f32 v119, v119
    v_exp_f32 v120, v120
    v_exp_f32 v121, v121
    v_exp_f32 v122, v122
    v_exp_f32 v123, v123
    v_exp_f32 v124, v124
    v_exp_f32 v125, v125
    v_exp_f32 v126, v126
    v_exp_f32 v127, v127
    s_nop 0
    v_add_f32 v30, v30, v64
    v_add_f32 v30, v30, v65
    v_add_f32 v30, v30, v66
    v_add_f32 v30, v30, v67
    v_add_f32 v30, v30, v68
    v_add_f32 v30, v30, v69
    v_add_f32 v30, v30, v70
    v_add_f32 v30, v30, v71
    v_add_f32 v30, v30, v72
    v_add_f32 v30, v30, v73
    v_add_f32 v30, v30, v74
    v_add_f32 v30, v30, v75
    v_add_f32 v30, v30, v76
    v_add_f32 v30, v30, v77
    v_add_f32 v30, v30, v78
    v_add_f32 v30, v30, v79
    v_add_f32 v30, v30, v80
    v_add_f32 v30, v30, v81
    v_add_f32 v30, v30, v82
    v_add_f32 v30, v30, v83
    v_add_f32 v30, v30, v84
    v_add_f32 v30, v30, v85
    v_add_f32 v30, v30, v86
    v_add_f32 v30, v30, v87
    v_add_f32 v30, v30, v88
    v_add_f32 v30, v30, v89
    v_add_f32 v30, v30, v90
    v_add_f32 v30, v30, v91
    v_add_f32 v30, v30, v92
    v_add_f32 v30, v30, v93
    v_add_f32 v30, v30, v94
    v_add_f32 v30, v30, v95
    v_add_f32 v30, v30, v96
    v_add_f32 v30, v30, v97
    v_add_f32 v30, v30, v98
    v_add_f32 v30, v30, v99
    v_add_f32 v30, v30, v100
    v_add_f32 v30, v30, v101
    v_add_f32 v30, v30, v102
    v_add_f32 v30, v30, v103
    v_add_f32 v30, v30, v104
    v_add_f32 v30, v30, v105
    v_add_f32 v30, v30, v106
    v_add_f32 v30, v30, v107
    v_add_f32 v30, v30, v108
    v_add_f32 v30, v30, v109
    v_add_f32 v30, v30, v110
    v_add_f32 v30, v30, v111
    v_add_f32 v30, v30, v112
    v_add_f32 v30, v30, v113
    v_add_f32 v30, v30, v114
    v_add_f32 v30, v30, v115
    v_add_f32 v30, v30, v116
    v_add_f32 v30, v30, v117
    v_add_f32 v30, v30, v118
    v_add_f32 v30, v30, v119
    v_add_f32 v30, v30, v120
    v_add_f32 v30, v30, v121
    v_add_f32 v30, v30, v122
    v_add_f32 v30, v30, v123
    v_add_f32 v30, v30, v124
    v_add_f32 v30, v30, v125
    v_add_f32 v30, v30, v126
    v_add_f32 v30, v30, v127
    v_mov_b32 v20, 0
    v_mov_b32 v21, 0
    v_mov_b32 v22, 0
    v_mov_b32 v23, 0
    v_mov_b32 v24, 0
    v_mov_b32 v25, 0
    v_mov_b32 v26, 0
    v_mov_b32 v27, 0
    s_waitcnt vmcnt(7)
    v_lshlrev_b32 v4, 16, v32
    v_and_b32 v5, 0xffff0000, v32
    v_lshlrev_b32 v8, 16, v33
    v_and_b32 v9, 0xffff0000, v33
    v_lshlrev_b32 v10, 16, v34
    v_and_b32 v11, 0xffff0000, v34
    v_lshlrev_b32 v14, 16, v35
    v_and_b32 v15, 0xffff0000, v35
    s_mov_b32 s92, 8192
    buffer_load_dwordx4 v[32:35], v2, s[44:47], s92 offen nt
    v_fmac_f32 v20, v64, v4
    v_fmac_f32 v21, v64, v5
    v_fmac_f32 v22, v64, v8
    v_fmac_f32 v23, v64, v9
    v_fmac_f32 v24, v64, v10
    v_fmac_f32 v25, v64, v11
    v_fmac_f32 v26, v64, v14
    v_fmac_f32 v27, v64, v15
    s_waitcnt vmcnt(7)
    v_lshlrev_b32 v4, 16, v36
    v_and_b32 v5, 0xffff0000, v36
    v_lshlrev_b32 v8, 16, v37
    v_and_b32 v9, 0xffff0000, v37
    v_lshlrev_b32 v10, 16, v38
    v_and_b32 v11, 0xffff0000, v38
    v_lshlrev_b32 v14, 16, v39
    v_and_b32 v15, 0xffff0000, v39
    s_mov_b32 s92, 8192
    buffer_load_dwordx4 v[36:39], v2, s[44:47], s92 offen offset:1024 nt
    v_fmac_f32 v20, v65, v4
    v_fmac_f32 v21, v65, v5
    v_fmac_f32 v22, v65, v8
    v_fmac_f32 v23, v65, v9
    v_fmac_f32 v24, v65, v10
    v_fmac_f32 v25, v65, v11
    v_fmac_f32 v26, v65, v14
    v_fmac_f32 v27, v65, v15
    s_waitcnt vmcnt(7)
    v_lshlrev_b32 v4, 16, v40
    v_and_b32 v5, 0xffff0000, v40
    v_lshlrev_b32 v8, 16, v41
    v_and_b32 v9, 0xffff0000, v41
    v_lshlrev_b32 v10, 16, v42
    v_and_b32 v11, 0xffff0000, v42
    v_lshlrev_b32 v14, 16, v43
    v_and_b32 v15, 0xffff0000, v43
    s_mov_b32 s92, 8192
    buffer_load_dwordx4 v[40:43], v2, s[44:47], s92 offen offset:2048 nt
    v_fmac_f32 v20, v66, v4
    v_fmac_f32 v21, v66, v5
    v_fmac_f32 v22, v66, v8
    v_fmac_f32 v23, v66, v9
    v_fmac_f32 v24, v66, v10
    v_fmac_f32 v25, v66, v11
    v_fmac_f32 v26, v66, v14
    v_fmac_f32 v27, v66, v15
    s_waitcnt vmcnt(7)
    v_lshlrev_b32 v4, 16, v44
    v_and_b32 v5, 0xffff0000, v44
    v_lshlrev_b32 v8, 16, v45
    v_and_b32 v9, 0xffff0000, v45
    v_lshlrev_b32 v10, 16, v46
    v_and_b32 v11, 0xffff0000, v46
    v_lshlrev_b32 v14, 16, v47
    v_and_b32 v15, 0xffff0000, v47
    s_mov_b32 s92, 8192
    buffer_load_dwordx4 v[44:47], v2, s[44:47], s92 offen offset:3072 nt
    v_fmac_f32 v20, v67, v4
    v_fmac_f32 v21, v67, v5
    v_fmac_f32 v22, v67, v8
    v_fmac_f32 v23, v67, v9
    v_fmac_f32 v24, v67, v10
    v_fmac_f32 v25, v67, v11
    v_fmac_f32 v26, v67, v14
    v_fmac_f32 v27, v67, v15
    s_waitcnt vmcnt(7)
    v_lshlrev_b32 v4, 16, v48
    v_and_b32 v5, 0xffff0000, v48
    v_lshlrev_b32 v8, 16, v49
    v_and_b32 v9, 0xffff0000, v49
    v_lshlrev_b32 v10, 16, v50
    v_and_b32 v11, 0xffff0000, v50
    v_lshlrev_b32 v14, 16, v51
    v_and_b32 v15, 0xffff0000, v51
    s_mov_b32 s92, 12288
    buffer_load_dwordx4 v[48:51], v2, s[44:47], s92 offen nt
    v_fmac_f32 v20, v68, v4
    v_fmac_f32 v21, v68, v5
    v_fmac_f32 v22, v68, v8
    v_fmac_f32 v23, v68, v9
    v_fmac_f32 v24, v68, v10
    v_fmac_f32 v25, v68, v11
    v_fmac_f32 v26, v68, v14
    v_fmac_f32 v27, v68, v15
    s_waitcnt vmcnt(7)
    v_lshlrev_b32 v4, 16, v52
    v_and_b32 v5, 0xffff0000, v52
    v_lshlrev_b32 v8, 16, v53
    v_and_b32 v9, 0xffff0000, v53
    v_lshlrev_b32 v10, 16, v54
    v_and_b32 v11, 0xffff0000, v54
    v_lshlrev_b32 v14, 16, v55
    v_and_b32 v15, 0xffff0000, v55
    s_mov_b32 s92, 12288
    buffer_load_dwordx4 v[52:55], v2, s[44:47], s92 offen offset:1024 nt
    v_fmac_f32 v20, v69, v4
    v_fmac_f32 v21, v69, v5
    v_fmac_f32 v22, v69, v8
    v_fmac_f32 v23, v69, v9
    v_fmac_f32 v24, v69, v10
    v_fmac_f32 v25, v69, v11
    v_fmac_f32 v26, v69, v14
    v_fmac_f32 v27, v69, v15
    s_waitcnt vmcnt(7)
    v_lshlrev_b32 v4, 16, v56
    v_and_b32 v5, 0xffff0000, v56
    v_lshlrev_b32 v8, 16, v57
    v_and_b32 v9, 0xffff0000, v57
    v_lshlrev_b32 v10, 16, v58
    v_and_b32 v11, 0xffff0000, v58
    v_lshlrev_b32 v14, 16, v59
    v_and_b32 v15, 0xffff0000, v59
    s_mov_b32 s92, 12288
    buffer_load_dwordx4 v[56:59], v2, s[44:47], s92 offen offset:2048 nt
    v_fmac_f32 v20, v70, v4
    v_fmac_f32 v21, v70, v5
    v_fmac_f32 v22, v70, v8
    v_fmac_f32 v23, v70, v9
    v_fmac_f32 v24, v70, v10
    v_fmac_f32 v25, v70, v11
    v_fmac_f32 v26, v70, v14
    v_fmac_f32 v27, v70, v15
    s_waitcnt vmcnt(7)
    v_lshlrev_b32 v4, 16, v60
    v_and_b32 v5, 0xffff0000, v60
    v_lshlrev_b32 v8, 16, v61
    v_and_b32 v9, 0xffff0000, v61
    v_lshlrev_b32 v10, 16, v62
    v_and_b32 v11, 0xffff0000, v62
    v_lshlrev_b32 v14, 16, v63
    v_and_b32 v15, 0xffff0000, v63
    s_mov_b32 s92, 12288
    buffer_load_dwordx4 v[60:63], v2, s[44:47], s92 offen offset:3072 nt
    v_fmac_f32 v20, v71, v4
    v_fmac_f32 v21, v71, v5
    v_fmac_f32 v22, v71, v8
    v_fmac_f32 v23, v71, v9
    v_fmac_f32 v24, v71, v10
    v_fmac_f32 v25, v71, v11
    v_fmac_f32 v26, v71, v14
    v_fmac_f32 v27, v71, v15
    s_waitcnt vmcnt(7)
    v_lshlrev_b32 v4, 16, v32
    v_and_b32 v5, 0xffff0000, v32
    v_lshlrev_b32 v8, 16, v33
    v_and_b32 v9, 0xffff0000, v33
    v_lshlrev_b32 v10, 16, v34
    v_and_b32 v11, 0xffff0000, v34
    v_lshlrev_b32 v14, 16, v35
    v_and_b32 v15, 0xffff0000, v35
    s_mov_b32 s92, 16384
    buffer_load_dwordx4 v[32:35], v2, s[44:47], s92 offen nt
    v_fmac_f32 v20, v72, v4
    v_fmac_f32 v21, v72, v5
    v_fmac_f32 v22, v72, v8
    v_fmac_f32 v23, v72, v9
    v_fmac_f32 v24, v72, v10
    v_fmac_f32 v25, v72, v11
    v_fmac_f32 v26, v72, v14
    v_fmac_f32 v27, v72, v15
    s_waitcnt vmcnt(7)
    v_lshlrev_b32 v4, 16, v36
    v_and_b32 v5, 0xffff0000, v36
    v_lshlrev_b32 v8, 16, v37
    v_and_b32 v9, 0xffff0000, v37
    v_lshlrev_b32 v10, 16, v38
    v_and_b32 v11, 0xffff0000, v38
    v_lshlrev_b32 v14, 16, v39
    v_and_b32 v15, 0xffff0000, v39
    s_mov_b32 s92, 16384
    buffer_load_dwordx4 v[36:39], v2, s[44:47], s92 offen offset:1024 nt
    v_fmac_f32 v20, v73, v4
    v_fmac_f32 v21, v73, v5
    v_fmac_f32 v22, v73, v8
    v_fmac_f32 v23, v73, v9
    v_fmac_f32 v24, v73, v10
    v_fmac_f32 v25, v73, v11
    v_fmac_f32 v26, v73, v14
    v_fmac_f32 v27, v73, v15
    s_waitcnt vmcnt(7)
    v_lshlrev_b32 v4, 16, v40
    v_and_b32 v5, 0xffff0000, v40
    v_lshlrev_b32 v8, 16, v41
    v_and_b32 v9, 0xffff0000, v41
    v_lshlrev_b32 v10, 16, v42
    v_and_b32 v11, 0xffff0000, v42
    v_lshlrev_b32 v14, 16, v43
    v_and_b32 v15, 0xffff0000, v43
    s_mov_b32 s92, 16384
    buffer_load_dwordx4 v[40:43], v2, s[44:47], s92 offen offset:2048 nt
    v_fmac_f32 v20, v74, v4
    v_fmac_f32 v21, v74, v5
    v_fmac_f32 v22, v74, v8
    v_fmac_f32 v23, v74, v9
    v_fmac_f32 v24, v74, v10
    v_fmac_f32 v25, v74, v11
    v_fmac_f32 v26, v74, v14
    v_fmac_f32 v27, v74, v15
    s_waitcnt vmcnt(7)
    v_lshlrev_b32 v4, 16, v44
    v_and_b32 v5, 0xffff0000, v44
    v_lshlrev_b32 v8, 16, v45
    v_and_b32 v9, 0xffff0000, v45
    v_lshlrev_b32 v10, 16, v46
    v_and_b32 v11, 0xffff0000, v46
    v_lshlrev_b32 v14, 16, v47
    v_and_b32 v15, 0xffff0000, v47
    s_mov_b32 s92, 16384
    buffer_load_dwordx4 v[44:47], v2, s[44:47], s92 offen offset:3072 nt
    v_fmac_f32 v20, v75, v4
    v_fmac_f32 v21, v75, v5
    v_fmac_f32 v22, v75, v8
    v_fmac_f32 v23, v75, v9
    v_fmac_f32 v24, v75, v10
    v_fmac_f32 v25, v75, v11
    v_fmac_f32 v26, v75, v14
    v_fmac_f32 v27, v75, v15
    s_waitcnt vmcnt(7)
    v_lshlrev_b32 v4, 16, v48
    v_and_b32 v5, 0xffff0000, v48
    v_lshlrev_b32 v8, 16, v49
    v_and_b32 v9, 0xffff0000, v49
    v_lshlrev_b32 v10, 16, v50
    v_and_b32 v11, 0xffff0000, v50
    v_lshlrev_b32 v14, 16, v51
    v_and_b32 v15, 0xffff0000, v51
    s_mov_b32 s92, 20480
    buffer_load_dwordx4 v[48:51], v2, s[44:47], s92 offen nt
    v_fmac_f32 v20, v76, v4
    v_fmac_f32 v21, v76, v5
    v_fmac_f32 v22, v76, v8
    v_fmac_f32 v23, v76, v9
    v_fmac_f32 v24, v76, v10
    v_fmac_f32 v25, v76, v11
    v_fmac_f32 v26, v76, v14
    v_fmac_f32 v27, v76, v15
    s_waitcnt vmcnt(7)
    v_lshlrev_b32 v4, 16, v52
    v_and_b32 v5, 0xffff0000, v52
    v_lshlrev_b32 v8, 16, v53
    v_and_b32 v9, 0xffff0000, v53
    v_lshlrev_b32 v10, 16, v54
    v_and_b32 v11, 0xffff0000, v54
    v_lshlrev_b32 v14, 16, v55
    v_and_b32 v15, 0xffff0000, v55
    s_mov_b32 s92, 20480
    buffer_load_dwordx4 v[52:55], v2, s[44:47], s92 offen offset:1024 nt
    v_fmac_f32 v20, v77, v4
    v_fmac_f32 v21, v77, v5
    v_fmac_f32 v22, v77, v8
    v_fmac_f32 v23, v77, v9
    v_fmac_f32 v24, v77, v10
    v_fmac_f32 v25, v77, v11
    v_fmac_f32 v26, v77, v14
    v_fmac_f32 v27, v77, v15
    s_waitcnt vmcnt(7)
    v_lshlrev_b32 v4, 16, v56
    v_and_b32 v5, 0xffff0000, v56
    v_lshlrev_b32 v8, 16, v57
    v_and_b32 v9, 0xffff0000, v57
    v_lshlrev_b32 v10, 16, v58
    v_and_b32 v11, 0xffff0000, v58
    v_lshlrev_b32 v14, 16, v59
    v_and_b32 v15, 0xffff0000, v59
    s_mov_b32 s92, 20480
    buffer_load_dwordx4 v[56:59], v2, s[44:47], s92 offen offset:2048 nt
    v_fmac_f32 v20, v78, v4
    v_fmac_f32 v21, v78, v5
    v_fmac_f32 v22, v78, v8
    v_fmac_f32 v23, v78, v9
    v_fmac_f32 v24, v78, v10
    v_fmac_f32 v25, v78, v11
    v_fmac_f32 v26, v78, v14
    v_fmac_f32 v27, v78, v15
    s_waitcnt vmcnt(7)
    v_lshlrev_b32 v4, 16, v60
    v_and_b32 v5, 0xffff0000, v60
    v_lshlrev_b32 v8, 16, v61
    v_and_b32 v9, 0xffff0000, v61
    v_lshlrev_b32 v10, 16, v62
    v_and_b32 v11, 0xffff0000, v62
    v_lshlrev_b32 v14, 16, v63
    v_and_b32 v15, 0xffff0000, v63
    s_mov_b32 s92, 20480
    buffer_load_dwordx4 v[60:63], v2, s[44:47], s92 offen offset:3072 nt
    v_fmac_f32 v20, v79, v4
    v_fmac_f32 v21, v79, v5
    v_fmac_f32 v22, v79, v8
    v_fmac_f32 v23, v79, v9
    v_fmac_f32 v24, v79, v10
    v_fmac_f32 v25, v79, v11
    v_fmac_f32 v26, v79, v14
    v_fmac_f32 v27, v79, v15
    s_waitcnt vmcnt(7)
    v_lshlrev_b32 v4, 16, v32
    v_and_b32 v5, 0xffff0000, v32
    v_lshlrev_b32 v8, 16, v33
    v_and_b32 v9, 0xffff0000, v33
    v_lshlrev_b32 v10, 16, v34
    v_and_b32 v11, 0xffff0000, v34
    v_lshlrev_b32 v14, 16, v35
    v_and_b32 v15, 0xffff0000, v35
    s_mov_b32 s92, 24576
    buffer_load_dwordx4 v[32:35], v2, s[44:47], s92 offen nt
    v_fmac_f32 v20, v80, v4
    v_fmac_f32 v21, v80, v5
    v_fmac_f32 v22, v80, v8
    v_fmac_f32 v23, v80, v9
    v_fmac_f32 v24, v80, v10
    v_fmac_f32 v25, v80, v11
    v_fmac_f32 v26, v80, v14
    v_fmac_f32 v27, v80, v15
    s_waitcnt vmcnt(7)
    v_lshlrev_b32 v4, 16, v36
    v_and_b32 v5, 0xffff0000, v36
    v_lshlrev_b32 v8, 16, v37
    v_and_b32 v9, 0xffff0000, v37
    v_lshlrev_b32 v10, 16, v38
    v_and_b32 v11, 0xffff0000, v38
    v_lshlrev_b32 v14, 16, v39
    v_and_b32 v15, 0xffff0000, v39
    s_mov_b32 s92, 24576
    buffer_load_dwordx4 v[36:39], v2, s[44:47], s92 offen offset:1024 nt
    v_fmac_f32 v20, v81, v4
    v_fmac_f32 v21, v81, v5
    v_fmac_f32 v22, v81, v8
    v_fmac_f32 v23, v81, v9
    v_fmac_f32 v24, v81, v10
    v_fmac_f32 v25, v81, v11
    v_fmac_f32 v26, v81, v14
    v_fmac_f32 v27, v81, v15
    s_waitcnt vmcnt(7)
    v_lshlrev_b32 v4, 16, v40
    v_and_b32 v5, 0xffff0000, v40
    v_lshlrev_b32 v8, 16, v41
    v_and_b32 v9, 0xffff0000, v41
    v_lshlrev_b32 v10, 16, v42
    v_and_b32 v11, 0xffff0000, v42
    v_lshlrev_b32 v14, 16, v43
    v_and_b32 v15, 0xffff0000, v43
    s_mov_b32 s92, 24576
    buffer_load_dwordx4 v[40:43], v2, s[44:47], s92 offen offset:2048 nt
    v_fmac_f32 v20, v82, v4
    v_fmac_f32 v21, v82, v5
    v_fmac_f32 v22, v82, v8
    v_fmac_f32 v23, v82, v9
    v_fmac_f32 v24, v82, v10
    v_fmac_f32 v25, v82, v11
    v_fmac_f32 v26, v82, v14
    v_fmac_f32 v27, v82, v15
    s_waitcnt vmcnt(7)
    v_lshlrev_b32 v4, 16, v44
    v_and_b32 v5, 0xffff0000, v44
    v_lshlrev_b32 v8, 16, v45
    v_and_b32 v9, 0xffff0000, v45
    v_lshlrev_b32 v10, 16, v46
    v_and_b32 v11, 0xffff0000, v46
    v_lshlrev_b32 v14, 16, v47
    v_and_b32 v15, 0xffff0000, v47
    s_mov_b32 s92, 24576
    buffer_load_dwordx4 v[44:47], v2, s[44:47], s92 offen offset:3072 nt
    v_fmac_f32 v20, v83, v4
    v_fmac_f32 v21, v83, v5
    v_fmac_f32 v22, v83, v8
    v_fmac_f32 v23, v83, v9
    v_fmac_f32 v24, v83, v10
    v_fmac_f32 v25, v83, v11
    v_fmac_f32 v26, v83, v14
    v_fmac_f32 v27, v83, v15
    s_waitcnt vmcnt(7)
    v_lshlrev_b32 v4, 16, v48
    v_and_b32 v5, 0xffff0000, v48
    v_lshlrev_b32 v8, 16, v49
    v_and_b32 v9, 0xffff0000, v49
    v_lshlrev_b32 v10, 16, v50
    v_and_b32 v11, 0xffff0000, v50
    v_lshlrev_b32 v14, 16, v51
    v_and_b32 v15, 0xffff0000, v51
    s_mov_b32 s92, 28672
    buffer_load_dwordx4 v[48:51], v2, s[44:47], s92 offen nt
    v_fmac_f32 v20, v84, v4
    v_fmac_f32 v21, v84, v5
    v_fmac_f32 v22, v84, v8
    v_fmac_f32 v23, v84, v9
    v_fmac_f32 v24, v84, v10
    v_fmac_f32 v25, v84, v11
    v_fmac_f32 v26, v84, v14
    v_fmac_f32 v27, v84, v15
    s_waitcnt vmcnt(7)
    v_lshlrev_b32 v4, 16, v52
    v_and_b32 v5, 0xffff0000, v52
    v_lshlrev_b32 v8, 16, v53
    v_and_b32 v9, 0xffff0000, v53
    v_lshlrev_b32 v10, 16, v54
    v_and_b32 v11, 0xffff0000, v54
    v_lshlrev_b32 v14, 16, v55
    v_and_b32 v15, 0xffff0000, v55
    s_mov_b32 s92, 28672
    buffer_load_dwordx4 v[52:55], v2, s[44:47], s92 offen offset:1024 nt
    v_fmac_f32 v20, v85, v4
    v_fmac_f32 v21, v85, v5
    v_fmac_f32 v22, v85, v8
    v_fmac_f32 v23, v85, v9
    v_fmac_f32 v24, v85, v10
    v_fmac_f32 v25, v85, v11
    v_fmac_f32 v26, v85, v14
    v_fmac_f32 v27, v85, v15
    s_waitcnt vmcnt(7)
    v_lshlrev_b32 v4, 16, v56
    v_and_b32 v5, 0xffff0000, v56
    v_lshlrev_b32 v8, 16, v57
    v_and_b32 v9, 0xffff0000, v57
    v_lshlrev_b32 v10, 16, v58
    v_and_b32 v11, 0xffff0000, v58
    v_lshlrev_b32 v14, 16, v59
    v_and_b32 v15, 0xffff0000, v59
    s_mov_b32 s92, 28672
    buffer_load_dwordx4 v[56:59], v2, s[44:47], s92 offen offset:2048 nt
    v_fmac_f32 v20, v86, v4
    v_fmac_f32 v21, v86, v5
    v_fmac_f32 v22, v86, v8
    v_fmac_f32 v23, v86, v9
    v_fmac_f32 v24, v86, v10
    v_fmac_f32 v25, v86, v11
    v_fmac_f32 v26, v86, v14
    v_fmac_f32 v27, v86, v15
    s_waitcnt vmcnt(7)
    v_lshlrev_b32 v4, 16, v60
    v_and_b32 v5, 0xffff0000, v60
    v_lshlrev_b32 v8, 16, v61
    v_and_b32 v9, 0xffff0000, v61
    v_lshlrev_b32 v10, 16, v62
    v_and_b32 v11, 0xffff0000, v62
    v_lshlrev_b32 v14, 16, v63
    v_and_b32 v15, 0xffff0000, v63
    s_mov_b32 s92, 28672
    buffer_load_dwordx4 v[60:63], v2, s[44:47], s92 offen offset:3072 nt
    v_fmac_f32 v20, v87, v4
    v_fmac_f32 v21, v87, v5
    v_fmac_f32 v22, v87, v8
    v_fmac_f32 v23, v87, v9
    v_fmac_f32 v24, v87, v10
    v_fmac_f32 v25, v87, v11
    v_fmac_f32 v26, v87, v14
    v_fmac_f32 v27, v87, v15
    s_waitcnt vmcnt(7)
    v_lshlrev_b32 v4, 16, v32
    v_and_b32 v5, 0xffff0000, v32
    v_lshlrev_b32 v8, 16, v33
    v_and_b32 v9, 0xffff0000, v33
    v_lshlrev_b32 v10, 16, v34
    v_and_b32 v11, 0xffff0000, v34
    v_lshlrev_b32 v14, 16, v35
    v_and_b32 v15, 0xffff0000, v35
    s_mov_b32 s92, 32768
    buffer_load_dwordx4 v[32:35], v2, s[44:47], s92 offen nt
    v_fmac_f32 v20, v88, v4
    v_fmac_f32 v21, v88, v5
    v_fmac_f32 v22, v88, v8
    v_fmac_f32 v23, v88, v9
    v_fmac_f32 v24, v88, v10
    v_fmac_f32 v25, v88, v11
    v_fmac_f32 v26, v88, v14
    v_fmac_f32 v27, v88, v15
    s_waitcnt vmcnt(7)
    v_lshlrev_b32 v4, 16, v36
    v_and_b32 v5, 0xffff0000, v36
    v_lshlrev_b32 v8, 16, v37
    v_and_b32 v9, 0xffff0000, v37
    v_lshlrev_b32 v10, 16, v38
    v_and_b32 v11, 0xffff0000, v38
    v_lshlrev_b32 v14, 16, v39
    v_and_b32 v15, 0xffff0000, v39
    s_mov_b32 s92, 32768
    buffer_load_dwordx4 v[36:39], v2, s[44:47], s92 offen offset:1024 nt
    v_fmac_f32 v20, v89, v4
    v_fmac_f32 v21, v89, v5
    v_fmac_f32 v22, v89, v8
    v_fmac_f32 v23, v89, v9
    v_fmac_f32 v24, v89, v10
    v_fmac_f32 v25, v89, v11
    v_fmac_f32 v26, v89, v14
    v_fmac_f32 v27, v89, v15
    s_waitcnt vmcnt(7)
    v_lshlrev_b32 v4, 16, v40
    v_and_b32 v5, 0xffff0000, v40
    v_lshlrev_b32 v8, 16, v41
    v_and_b32 v9, 0xffff0000, v41
    v_lshlrev_b32 v10, 16, v42
    v_and_b32 v11, 0xffff0000, v42
    v_lshlrev_b32 v14, 16, v43
    v_and_b32 v15, 0xffff0000, v43
    s_mov_b32 s92, 32768
    buffer_load_dwordx4 v[40:43], v2, s[44:47], s92 offen offset:2048 nt
    v_fmac_f32 v20, v90, v4
    v_fmac_f32 v21, v90, v5
    v_fmac_f32 v22, v90, v8
    v_fmac_f32 v23, v90, v9
    v_fmac_f32 v24, v90, v10
    v_fmac_f32 v25, v90, v11
    v_fmac_f32 v26, v90, v14
    v_fmac_f32 v27, v90, v15
    s_waitcnt vmcnt(7)
    v_lshlrev_b32 v4, 16, v44
    v_and_b32 v5, 0xffff0000, v44
    v_lshlrev_b32 v8, 16, v45
    v_and_b32 v9, 0xffff0000, v45
    v_lshlrev_b32 v10, 16, v46
    v_and_b32 v11, 0xffff0000, v46
    v_lshlrev_b32 v14, 16, v47
    v_and_b32 v15, 0xffff0000, v47
    s_mov_b32 s92, 32768
    buffer_load_dwordx4 v[44:47], v2, s[44:47], s92 offen offset:3072 nt
    v_fmac_f32 v20, v91, v4
    v_fmac_f32 v21, v91, v5
    v_fmac_f32 v22, v91, v8
    v_fmac_f32 v23, v91, v9
    v_fmac_f32 v24, v91, v10
    v_fmac_f32 v25, v91, v11
    v_fmac_f32 v26, v91, v14
    v_fmac_f32 v27, v91, v15
    s_waitcnt vmcnt(7)
    v_lshlrev_b32 v4, 16, v48
    v_and_b32 v5, 0xffff0000, v48
    v_lshlrev_b32 v8, 16, v49
    v_and_b32 v9, 0xffff0000, v49
    v_lshlrev_b32 v10, 16, v50
    v_and_b32 v11, 0xffff0000, v50
    v_lshlrev_b32 v14, 16, v51
    v_and_b32 v15, 0xffff0000, v51
    s_mov_b32 s92, 36864
    buffer_load_dwordx4 v[48:51], v2, s[44:47], s92 offen nt
    v_fmac_f32 v20, v92, v4
    v_fmac_f32 v21, v92, v5
    v_fmac_f32 v22, v92, v8
    v_fmac_f32 v23, v92, v9
    v_fmac_f32 v24, v92, v10
    v_fmac_f32 v25, v92, v11
    v_fmac_f32 v26, v92, v14
    v_fmac_f32 v27, v92, v15
    s_waitcnt vmcnt(7)
    v_lshlrev_b32 v4, 16, v52
    v_and_b32 v5, 0xffff0000, v52
    v_lshlrev_b32 v8, 16, v53
    v_and_b32 v9, 0xffff0000, v53
    v_lshlrev_b32 v10, 16, v54
    v_and_b32 v11, 0xffff0000, v54
    v_lshlrev_b32 v14, 16, v55
    v_and_b32 v15, 0xffff0000, v55
    s_mov_b32 s92, 36864
    buffer_load_dwordx4 v[52:55], v2, s[44:47], s92 offen offset:1024 nt
    v_fmac_f32 v20, v93, v4
    v_fmac_f32 v21, v93, v5
    v_fmac_f32 v22, v93, v8
    v_fmac_f32 v23, v93, v9
    v_fmac_f32 v24, v93, v10
    v_fmac_f32 v25, v93, v11
    v_fmac_f32 v26, v93, v14
    v_fmac_f32 v27, v93, v15
    s_waitcnt vmcnt(7)
    v_lshlrev_b32 v4, 16, v56
    v_and_b32 v5, 0xffff0000, v56
    v_lshlrev_b32 v8, 16, v57
    v_and_b32 v9, 0xffff0000, v57
    v_lshlrev_b32 v10, 16, v58
    v_and_b32 v11, 0xffff0000, v58
    v_lshlrev_b32 v14, 16, v59
    v_and_b32 v15, 0xffff0000, v59
    s_mov_b32 s92, 36864
    buffer_load_dwordx4 v[56:59], v2, s[44:47], s92 offen offset:2048 nt
    v_fmac_f32 v20, v94, v4
    v_fmac_f32 v21, v94, v5
    v_fmac_f32 v22, v94, v8
    v_fmac_f32 v23, v94, v9
    v_fmac_f32 v24, v94, v10
    v_fmac_f32 v25, v94, v11
    v_fmac_f32 v26, v94, v14
    v_fmac_f32 v27, v94, v15
    s_waitcnt vmcnt(7)
    v_lshlrev_b32 v4, 16, v60
    v_and_b32 v5, 0xffff0000, v60
    v_lshlrev_b32 v8, 16, v61
    v_and_b32 v9, 0xffff0000, v61
    v_lshlrev_b32 v10, 16, v62
    v_and_b32 v11, 0xffff0000, v62
    v_lshlrev_b32 v14, 16, v63
    v_and_b32 v15, 0xffff0000, v63
    s_mov_b32 s92, 36864
    buffer_load_dwordx4 v[60:63], v2, s[44:47], s92 offen offset:3072 nt
    v_fmac_f32 v20, v95, v4
    v_fmac_f32 v21, v95, v5
    v_fmac_f32 v22, v95, v8
    v_fmac_f32 v23, v95, v9
    v_fmac_f32 v24, v95, v10
    v_fmac_f32 v25, v95, v11
    v_fmac_f32 v26, v95, v14
    v_fmac_f32 v27, v95, v15
    s_movk_i32 s92, 0
    buffer_load_dwordx4 v[64:67], v31, s[52:55], s92 offen offset:0
    s_movk_i32 s92, 0
    buffer_load_dwordx4 v[68:71], v31, s[52:55], s92 offen offset:1024
    s_movk_i32 s92, 0
    buffer_load_dwordx4 v[72:75], v31, s[52:55], s92 offen offset:2048
    s_movk_i32 s92, 0
    buffer_load_dwordx4 v[76:79], v31, s[52:55], s92 offen offset:3072
    s_movk_i32 s92, 4096
    buffer_load_dwordx4 v[80:83], v31, s[52:55], s92 offen offset:0
    s_movk_i32 s92, 4096
    buffer_load_dwordx4 v[84:87], v31, s[52:55], s92 offen offset:1024
    s_movk_i32 s92, 4096
    buffer_load_dwordx4 v[88:91], v31, s[52:55], s92 offen offset:2048
    s_movk_i32 s92, 4096
    buffer_load_dwordx4 v[92:95], v31, s[52:55], s92 offen offset:3072
    s_waitcnt vmcnt(15)
    v_lshlrev_b32 v4, 16, v32
    v_and_b32 v5, 0xffff0000, v32
    v_lshlrev_b32 v8, 16, v33
    v_and_b32 v9, 0xffff0000, v33
    v_lshlrev_b32 v10, 16, v34
    v_and_b32 v11, 0xffff0000, v34
    v_lshlrev_b32 v14, 16, v35
    v_and_b32 v15, 0xffff0000, v35
    s_mov_b32 s92, 40960
    buffer_load_dwordx4 v[32:35], v2, s[44:47], s92 offen nt
    v_fmac_f32 v20, v96, v4
    v_fmac_f32 v21, v96, v5
    v_fmac_f32 v22, v96, v8
    v_fmac_f32 v23, v96, v9
    v_fmac_f32 v24, v96, v10
    v_fmac_f32 v25, v96, v11
    v_fmac_f32 v26, v96, v14
    v_fmac_f32 v27, v96, v15
    s_waitcnt vmcnt(15)
    v_lshlrev_b32 v4, 16, v36
    v_and_b32 v5, 0xffff0000, v36
    v_lshlrev_b32 v8, 16, v37
    v_and_b32 v9, 0xffff0000, v37
    v_lshlrev_b32 v10, 16, v38
    v_and_b32 v11, 0xffff0000, v38
    v_lshlrev_b32 v14, 16, v39
    v_and_b32 v15, 0xffff0000, v39
    s_mov_b32 s92, 40960
    buffer_load_dwordx4 v[36:39], v2, s[44:47], s92 offen offset:1024 nt
    v_fmac_f32 v20, v97, v4
    v_fmac_f32 v21, v97, v5
    v_fmac_f32 v22, v97, v8
    v_fmac_f32 v23, v97, v9
    v_fmac_f32 v24, v97, v10
    v_fmac_f32 v25, v97, v11
    v_fmac_f32 v26, v97, v14
    v_fmac_f32 v27, v97, v15
    s_waitcnt vmcnt(15)
    v_lshlrev_b32 v4, 16, v40
    v_and_b32 v5, 0xffff0000, v40
    v_lshlrev_b32 v8, 16, v41
    v_and_b32 v9, 0xffff0000, v41
    v_lshlrev_b32 v10, 16, v42
    v_and_b32 v11, 0xffff0000, v42
    v_lshlrev_b32 v14, 16, v43
    v_and_b32 v15, 0xffff0000, v43
    s_mov_b32 s92, 40960
    buffer_load_dwordx4 v[40:43], v2, s[44:47], s92 offen offset:2048 nt
    v_fmac_f32 v20, v98, v4
    v_fmac_f32 v21, v98, v5
    v_fmac_f32 v22, v98, v8
    v_fmac_f32 v23, v98, v9
    v_fmac_f32 v24, v98, v10
    v_fmac_f32 v25, v98, v11
    v_fmac_f32 v26, v98, v14
    v_fmac_f32 v27, v98, v15
    s_waitcnt vmcnt(15)
    v_lshlrev_b32 v4, 16, v44
    v_and_b32 v5, 0xffff0000, v44
    v_lshlrev_b32 v8, 16, v45
    v_and_b32 v9, 0xffff0000, v45
    v_lshlrev_b32 v10, 16, v46
    v_and_b32 v11, 0xffff0000, v46
    v_lshlrev_b32 v14, 16, v47
    v_and_b32 v15, 0xffff0000, v47
    s_mov_b32 s92, 40960
    buffer_load_dwordx4 v[44:47], v2, s[44:47], s92 offen offset:3072 nt
    v_fmac_f32 v20, v99, v4
    v_fmac_f32 v21, v99, v5
    v_fmac_f32 v22, v99, v8
    v_fmac_f32 v23, v99, v9
    v_fmac_f32 v24, v99, v10
    v_fmac_f32 v25, v99, v11
    v_fmac_f32 v26, v99, v14
    v_fmac_f32 v27, v99, v15
    s_waitcnt vmcnt(15)
    v_lshlrev_b32 v4, 16, v48
    v_and_b32 v5, 0xffff0000, v48
    v_lshlrev_b32 v8, 16, v49
    v_and_b32 v9, 0xffff0000, v49
    v_lshlrev_b32 v10, 16, v50
    v_and_b32 v11, 0xffff0000, v50
    v_lshlrev_b32 v14, 16, v51
    v_and_b32 v15, 0xffff0000, v51
    s_mov_b32 s92, 45056
    buffer_load_dwordx4 v[48:51], v2, s[44:47], s92 offen nt
    v_fmac_f32 v20, v100, v4
    v_fmac_f32 v21, v100, v5
    v_fmac_f32 v22, v100, v8
    v_fmac_f32 v23, v100, v9
    v_fmac_f32 v24, v100, v10
    v_fmac_f32 v25, v100, v11
    v_fmac_f32 v26, v100, v14
    v_fmac_f32 v27, v100, v15
    s_waitcnt vmcnt(15)
    v_lshlrev_b32 v4, 16, v52
    v_and_b32 v5, 0xffff0000, v52
    v_lshlrev_b32 v8, 16, v53
    v_and_b32 v9, 0xffff0000, v53
    v_lshlrev_b32 v10, 16, v54
    v_and_b32 v11, 0xffff0000, v54
    v_lshlrev_b32 v14, 16, v55
    v_and_b32 v15, 0xffff0000, v55
    s_mov_b32 s92, 45056
    buffer_load_dwordx4 v[52:55], v2, s[44:47], s92 offen offset:1024 nt
    v_fmac_f32 v20, v101, v4
    v_fmac_f32 v21, v101, v5
    v_fmac_f32 v22, v101, v8
    v_fmac_f32 v23, v101, v9
    v_fmac_f32 v24, v101, v10
    v_fmac_f32 v25, v101, v11
    v_fmac_f32 v26, v101, v14
    v_fmac_f32 v27, v101, v15
    s_waitcnt vmcnt(15)
    v_lshlrev_b32 v4, 16, v56
    v_and_b32 v5, 0xffff0000, v56
    v_lshlrev_b32 v8, 16, v57
    v_and_b32 v9, 0xffff0000, v57
    v_lshlrev_b32 v10, 16, v58
    v_and_b32 v11, 0xffff0000, v58
    v_lshlrev_b32 v14, 16, v59
    v_and_b32 v15, 0xffff0000, v59
    s_mov_b32 s92, 45056
    buffer_load_dwordx4 v[56:59], v2, s[44:47], s92 offen offset:2048 nt
    v_fmac_f32 v20, v102, v4
    v_fmac_f32 v21, v102, v5
    v_fmac_f32 v22, v102, v8
    v_fmac_f32 v23, v102, v9
    v_fmac_f32 v24, v102, v10
    v_fmac_f32 v25, v102, v11
    v_fmac_f32 v26, v102, v14
    v_fmac_f32 v27, v102, v15
    s_waitcnt vmcnt(15)
    v_lshlrev_b32 v4, 16, v60
    v_and_b32 v5, 0xffff0000, v60
    v_lshlrev_b32 v8, 16, v61
    v_and_b32 v9, 0xffff0000, v61
    v_lshlrev_b32 v10, 16, v62
    v_and_b32 v11, 0xffff0000, v62
    v_lshlrev_b32 v14, 16, v63
    v_and_b32 v15, 0xffff0000, v63
    s_mov_b32 s92, 45056
    buffer_load_dwordx4 v[60:63], v2, s[44:47], s92 offen offset:3072 nt
    v_fmac_f32 v20, v103, v4
    v_fmac_f32 v21, v103, v5
    v_fmac_f32 v22, v103, v8
    v_fmac_f32 v23, v103, v9
    v_fmac_f32 v24, v103, v10
    v_fmac_f32 v25, v103, v11
    v_fmac_f32 v26, v103, v14
    v_fmac_f32 v27, v103, v15
    s_waitcnt vmcnt(7)
    v_lshlrev_b32 v4, 16, v32
    v_and_b32 v5, 0xffff0000, v32
    v_lshlrev_b32 v8, 16, v33
    v_and_b32 v9, 0xffff0000, v33
    v_lshlrev_b32 v10, 16, v34
    v_and_b32 v11, 0xffff0000, v34
    v_lshlrev_b32 v14, 16, v35
    v_and_b32 v15, 0xffff0000, v35
    s_mov_b32 s92, 49152
    buffer_load_dwordx4 v[32:35], v2, s[44:47], s92 offen nt
    v_fmac_f32 v20, v104, v4
    v_fmac_f32 v21, v104, v5
    v_fmac_f32 v22, v104, v8
    v_fmac_f32 v23, v104, v9
    v_fmac_f32 v24, v104, v10
    v_fmac_f32 v25, v104, v11
    v_fmac_f32 v26, v104, v14
    v_fmac_f32 v27, v104, v15
    s_waitcnt vmcnt(7)
    v_lshlrev_b32 v4, 16, v36
    v_and_b32 v5, 0xffff0000, v36
    v_lshlrev_b32 v8, 16, v37
    v_and_b32 v9, 0xffff0000, v37
    v_lshlrev_b32 v10, 16, v38
    v_and_b32 v11, 0xffff0000, v38
    v_lshlrev_b32 v14, 16, v39
    v_and_b32 v15, 0xffff0000, v39
    s_mov_b32 s92, 49152
    buffer_load_dwordx4 v[36:39], v2, s[44:47], s92 offen offset:1024 nt
    v_fmac_f32 v20, v105, v4
    v_fmac_f32 v21, v105, v5
    v_fmac_f32 v22, v105, v8
    v_fmac_f32 v23, v105, v9
    v_fmac_f32 v24, v105, v10
    v_fmac_f32 v25, v105, v11
    v_fmac_f32 v26, v105, v14
    v_fmac_f32 v27, v105, v15
    s_waitcnt vmcnt(7)
    v_lshlrev_b32 v4, 16, v40
    v_and_b32 v5, 0xffff0000, v40
    v_lshlrev_b32 v8, 16, v41
    v_and_b32 v9, 0xffff0000, v41
    v_lshlrev_b32 v10, 16, v42
    v_and_b32 v11, 0xffff0000, v42
    v_lshlrev_b32 v14, 16, v43
    v_and_b32 v15, 0xffff0000, v43
    s_mov_b32 s92, 49152
    buffer_load_dwordx4 v[40:43], v2, s[44:47], s92 offen offset:2048 nt
    v_fmac_f32 v20, v106, v4
    v_fmac_f32 v21, v106, v5
    v_fmac_f32 v22, v106, v8
    v_fmac_f32 v23, v106, v9
    v_fmac_f32 v24, v106, v10
    v_fmac_f32 v25, v106, v11
    v_fmac_f32 v26, v106, v14
    v_fmac_f32 v27, v106, v15
    s_waitcnt vmcnt(7)
    v_lshlrev_b32 v4, 16, v44
    v_and_b32 v5, 0xffff0000, v44
    v_lshlrev_b32 v8, 16, v45
    v_and_b32 v9, 0xffff0000, v45
    v_lshlrev_b32 v10, 16, v46
    v_and_b32 v11, 0xffff0000, v46
    v_lshlrev_b32 v14, 16, v47
    v_and_b32 v15, 0xffff0000, v47
    s_mov_b32 s92, 49152
    buffer_load_dwordx4 v[44:47], v2, s[44:47], s92 offen offset:3072 nt
    v_fmac_f32 v20, v107, v4
    v_fmac_f32 v21, v107, v5
    v_fmac_f32 v22, v107, v8
    v_fmac_f32 v23, v107, v9
    v_fmac_f32 v24, v107, v10
    v_fmac_f32 v25, v107, v11
    v_fmac_f32 v26, v107, v14
    v_fmac_f32 v27, v107, v15
    s_lshl_b32 s7, s90, 3
    s_mul_i32 s8, s6, 3
    s_add_u32 s7, s7, s8
    s_lshl_b32 s7, s7, 10
    v_lshlrev_b32 v3, 4, v1
    buffer_load_dwordx4 v[96:99], v3, s[64:67], s7 offen
    buffer_load_dwordx4 v[100:103], v3, s[64:67], s7 offen offset:1024
    buffer_load_dwordx4 v[104:107], v3, s[64:67], s7 offen offset:2048
    s_waitcnt vmcnt(10)
    v_lshlrev_b32 v4, 16, v48
    v_and_b32 v5, 0xffff0000, v48
    v_lshlrev_b32 v8, 16, v49
    v_and_b32 v9, 0xffff0000, v49
    v_lshlrev_b32 v10, 16, v50
    v_and_b32 v11, 0xffff0000, v50
    v_lshlrev_b32 v14, 16, v51
    v_and_b32 v15, 0xffff0000, v51
    s_mov_b32 s92, 53248
    buffer_load_dwordx4 v[48:51], v2, s[44:47], s92 offen nt
    v_fmac_f32 v20, v108, v4
    v_fmac_f32 v21, v108, v5
    v_fmac_f32 v22, v108, v8
    v_fmac_f32 v23, v108, v9
    v_fmac_f32 v24, v108, v10
    v_fmac_f32 v25, v108, v11
    v_fmac_f32 v26, v108, v14
    v_fmac_f32 v27, v108, v15
    s_waitcnt vmcnt(10)
    v_lshlrev_b32 v4, 16, v52
    v_and_b32 v5, 0xffff0000, v52
    v_lshlrev_b32 v8, 16, v53
    v_and_b32 v9, 0xffff0000, v53
    v_lshlrev_b32 v10, 16, v54
    v_and_b32 v11, 0xffff0000, v54
    v_lshlrev_b32 v14, 16, v55
    v_and_b32 v15, 0xffff0000, v55
    s_mov_b32 s92, 53248
    buffer_load_dwordx4 v[52:55], v2, s[44:47], s92 offen offset:1024 nt
    v_fmac_f32 v20, v109, v4
    v_fmac_f32 v21, v109, v5
    v_fmac_f32 v22, v109, v8
    v_fmac_f32 v23, v109, v9
    v_fmac_f32 v24, v109, v10
    v_fmac_f32 v25, v109, v11
    v_fmac_f32 v26, v109, v14
    v_fmac_f32 v27, v109, v15
    s_waitcnt vmcnt(10)
    v_lshlrev_b32 v4, 16, v56
    v_and_b32 v5, 0xffff0000, v56
    v_lshlrev_b32 v8, 16, v57
    v_and_b32 v9, 0xffff0000, v57
    v_lshlrev_b32 v10, 16, v58
    v_and_b32 v11, 0xffff0000, v58
    v_lshlrev_b32 v14, 16, v59
    v_and_b32 v15, 0xffff0000, v59
    s_mov_b32 s92, 53248
    buffer_load_dwordx4 v[56:59], v2, s[44:47], s92 offen offset:2048 nt
    v_fmac_f32 v20, v110, v4
    v_fmac_f32 v21, v110, v5
    v_fmac_f32 v22, v110, v8
    v_fmac_f32 v23, v110, v9
    v_fmac_f32 v24, v110, v10
    v_fmac_f32 v25, v110, v11
    v_fmac_f32 v26, v110, v14
    v_fmac_f32 v27, v110, v15
    s_waitcnt vmcnt(10)
    v_lshlrev_b32 v4, 16, v60
    v_and_b32 v5, 0xffff0000, v60
    v_lshlrev_b32 v8, 16, v61
    v_and_b32 v9, 0xffff0000, v61
    v_lshlrev_b32 v10, 16, v62
    v_and_b32 v11, 0xffff0000, v62
    v_lshlrev_b32 v14, 16, v63
    v_and_b32 v15, 0xffff0000, v63
    s_mov_b32 s92, 53248
    buffer_load_dwordx4 v[60:63], v2, s[44:47], s92 offen offset:3072 nt
    v_fmac_f32 v20, v111, v4
    v_fmac_f32 v21, v111, v5
    v_fmac_f32 v22, v111, v8
    v_fmac_f32 v23, v111, v9
    v_fmac_f32 v24, v111, v10
    v_fmac_f32 v25, v111, v11
    v_fmac_f32 v26, v111, v14
    v_fmac_f32 v27, v111, v15
    s_waitcnt vmcnt(10)
    v_lshlrev_b32 v4, 16, v32
    v_and_b32 v5, 0xffff0000, v32
    v_lshlrev_b32 v8, 16, v33
    v_and_b32 v9, 0xffff0000, v33
    v_lshlrev_b32 v10, 16, v34
    v_and_b32 v11, 0xffff0000, v34
    v_lshlrev_b32 v14, 16, v35
    v_and_b32 v15, 0xffff0000, v35
    s_mov_b32 s92, 57344
    buffer_load_dwordx4 v[32:35], v2, s[44:47], s92 offen nt
    v_fmac_f32 v20, v112, v4
    v_fmac_f32 v21, v112, v5
    v_fmac_f32 v22, v112, v8
    v_fmac_f32 v23, v112, v9
    v_fmac_f32 v24, v112, v10
    v_fmac_f32 v25, v112, v11
    v_fmac_f32 v26, v112, v14
    v_fmac_f32 v27, v112, v15
    s_waitcnt vmcnt(10)
    v_lshlrev_b32 v4, 16, v36
    v_and_b32 v5, 0xffff0000, v36
    v_lshlrev_b32 v8, 16, v37
    v_and_b32 v9, 0xffff0000, v37
    v_lshlrev_b32 v10, 16, v38
    v_and_b32 v11, 0xffff0000, v38
    v_lshlrev_b32 v14, 16, v39
    v_and_b32 v15, 0xffff0000, v39
    s_mov_b32 s92, 57344
    buffer_load_dwordx4 v[36:39], v2, s[44:47], s92 offen offset:1024 nt
    v_fmac_f32 v20, v113, v4
    v_fmac_f32 v21, v113, v5
    v_fmac_f32 v22, v113, v8
    v_fmac_f32 v23, v113, v9
    v_fmac_f32 v24, v113, v10
    v_fmac_f32 v25, v113, v11
    v_fmac_f32 v26, v113, v14
    v_fmac_f32 v27, v113, v15
    s_waitcnt vmcnt(10)
    v_lshlrev_b32 v4, 16, v40
    v_and_b32 v5, 0xffff0000, v40
    v_lshlrev_b32 v8, 16, v41
    v_and_b32 v9, 0xffff0000, v41
    v_lshlrev_b32 v10, 16, v42
    v_and_b32 v11, 0xffff0000, v42
    v_lshlrev_b32 v14, 16, v43
    v_and_b32 v15, 0xffff0000, v43
    s_mov_b32 s92, 57344
    buffer_load_dwordx4 v[40:43], v2, s[44:47], s92 offen offset:2048 nt
    v_fmac_f32 v20, v114, v4
    v_fmac_f32 v21, v114, v5
    v_fmac_f32 v22, v114, v8
    v_fmac_f32 v23, v114, v9
    v_fmac_f32 v24, v114, v10
    v_fmac_f32 v25, v114, v11
    v_fmac_f32 v26, v114, v14
    v_fmac_f32 v27, v114, v15
    s_waitcnt vmcnt(10)
    v_lshlrev_b32 v4, 16, v44
    v_and_b32 v5, 0xffff0000, v44
    v_lshlrev_b32 v8, 16, v45
    v_and_b32 v9, 0xffff0000, v45
    v_lshlrev_b32 v10, 16, v46
    v_and_b32 v11, 0xffff0000, v46
    v_lshlrev_b32 v14, 16, v47
    v_and_b32 v15, 0xffff0000, v47
    s_mov_b32 s92, 57344
    buffer_load_dwordx4 v[44:47], v2, s[44:47], s92 offen offset:3072 nt
    v_fmac_f32 v20, v115, v4
    v_fmac_f32 v21, v115, v5
    v_fmac_f32 v22, v115, v8
    v_fmac_f32 v23, v115, v9
    v_fmac_f32 v24, v115, v10
    v_fmac_f32 v25, v115, v11
    v_fmac_f32 v26, v115, v14
    v_fmac_f32 v27, v115, v15
    s_waitcnt vmcnt(7)
    v_lshlrev_b32 v4, 16, v48
    v_and_b32 v5, 0xffff0000, v48
    v_lshlrev_b32 v8, 16, v49
    v_and_b32 v9, 0xffff0000, v49
    v_lshlrev_b32 v10, 16, v50
    v_and_b32 v11, 0xffff0000, v50
    v_lshlrev_b32 v14, 16, v51
    v_and_b32 v15, 0xffff0000, v51
    s_mov_b32 s92, 61440
    buffer_load_dwordx4 v[48:51], v2, s[44:47], s92 offen nt
    v_fmac_f32 v20, v116, v4
    v_fmac_f32 v21, v116, v5
    v_fmac_f32 v22, v116, v8
    v_fmac_f32 v23, v116, v9
    v_fmac_f32 v24, v116, v10
    v_fmac_f32 v25, v116, v11
    v_fmac_f32 v26, v116, v14
    v_fmac_f32 v27, v116, v15
    s_waitcnt vmcnt(7)
    v_lshlrev_b32 v4, 16, v52
    v_and_b32 v5, 0xffff0000, v52
    v_lshlrev_b32 v8, 16, v53
    v_and_b32 v9, 0xffff0000, v53
    v_lshlrev_b32 v10, 16, v54
    v_and_b32 v11, 0xffff0000, v54
    v_lshlrev_b32 v14, 16, v55
    v_and_b32 v15, 0xffff0000, v55
    s_mov_b32 s92, 61440
    buffer_load_dwordx4 v[52:55], v2, s[44:47], s92 offen offset:1024 nt
    v_fmac_f32 v20, v117, v4
    v_fmac_f32 v21, v117, v5
    v_fmac_f32 v22, v117, v8
    v_fmac_f32 v23, v117, v9
    v_fmac_f32 v24, v117, v10
    v_fmac_f32 v25, v117, v11
    v_fmac_f32 v26, v117, v14
    v_fmac_f32 v27, v117, v15
    s_waitcnt vmcnt(7)
    v_lshlrev_b32 v4, 16, v56
    v_and_b32 v5, 0xffff0000, v56
    v_lshlrev_b32 v8, 16, v57
    v_and_b32 v9, 0xffff0000, v57
    v_lshlrev_b32 v10, 16, v58
    v_and_b32 v11, 0xffff0000, v58
    v_lshlrev_b32 v14, 16, v59
    v_and_b32 v15, 0xffff0000, v59
    s_mov_b32 s92, 61440
    buffer_load_dwordx4 v[56:59], v2, s[44:47], s92 offen offset:2048 nt
    v_fmac_f32 v20, v118, v4
    v_fmac_f32 v21, v118, v5
    v_fmac_f32 v22, v118, v8
    v_fmac_f32 v23, v118, v9
    v_fmac_f32 v24, v118, v10
    v_fmac_f32 v25, v118, v11
    v_fmac_f32 v26, v118, v14
    v_fmac_f32 v27, v118, v15
    s_waitcnt vmcnt(7)
    v_lshlrev_b32 v4, 16, v60
    v_and_b32 v5, 0xffff0000, v60
    v_lshlrev_b32 v8, 16, v61
    v_and_b32 v9, 0xffff0000, v61
    v_lshlrev_b32 v10, 16, v62
    v_and_b32 v11, 0xffff0000, v62
    v_lshlrev_b32 v14, 16, v63
    v_and_b32 v15, 0xffff0000, v63
    s_mov_b32 s92, 61440
    buffer_load_dwordx4 v[60:63], v2, s[44:47], s92 offen offset:3072 nt
    v_fmac_f32 v20, v119, v4
    v_fmac_f32 v21, v119, v5
    v_fmac_f32 v22, v119, v8
    v_fmac_f32 v23, v119, v9
    v_fmac_f32 v24, v119, v10
    v_fmac_f32 v25, v119, v11
    v_fmac_f32 v26, v119, v14
    v_fmac_f32 v27, v119, v15
    s_waitcnt vmcnt(7)
    v_lshlrev_b32 v4, 16, v32
    v_and_b32 v5, 0xffff0000, v32
    v_lshlrev_b32 v8, 16, v33
    v_and_b32 v9, 0xffff0000, v33
    v_lshlrev_b32 v10, 16, v34
    v_and_b32 v11, 0xffff0000, v34
    v_lshlrev_b32 v14, 16, v35
    v_and_b32 v15, 0xffff0000, v35
    v_fmac_f32 v20, v120, v4
    v_fmac_f32 v21, v120, v5
    v_fmac_f32 v22, v120, v8
    v_fmac_f32 v23, v120, v9
    v_fmac_f32 v24, v120, v10
    v_fmac_f32 v25, v120, v11
    v_fmac_f32 v26, v120, v14
    v_fmac_f32 v27, v120, v15
    s_waitcnt vmcnt(6)
    v_lshlrev_b32 v4, 16, v36
    v_and_b32 v5, 0xffff0000, v36
    v_lshlrev_b32 v8, 16, v37
    v_and_b32 v9, 0xffff0000, v37
    v_lshlrev_b32 v10, 16, v38
    v_and_b32 v11, 0xffff0000, v38
    v_lshlrev_b32 v14, 16, v39
    v_and_b32 v15, 0xffff0000, v39
    v_fmac_f32 v20, v121, v4
    v_fmac_f32 v21, v121, v5
    v_fmac_f32 v22, v121, v8
    v_fmac_f32 v23, v121, v9
    v_fmac_f32 v24, v121, v10
    v_fmac_f32 v25, v121, v11
    v_fmac_f32 v26, v121, v14
    v_fmac_f32 v27, v121, v15
    s_waitcnt vmcnt(5)
    v_lshlrev_b32 v4, 16, v40
    v_and_b32 v5, 0xffff0000, v40
    v_lshlrev_b32 v8, 16, v41
    v_and_b32 v9, 0xffff0000, v41
    v_lshlrev_b32 v10, 16, v42
    v_and_b32 v11, 0xffff0000, v42
    v_lshlrev_b32 v14, 16, v43
    v_and_b32 v15, 0xffff0000, v43
    v_fmac_f32 v20, v122, v4
    v_fmac_f32 v21, v122, v5
    v_fmac_f32 v22, v122, v8
    v_fmac_f32 v23, v122, v9
    v_fmac_f32 v24, v122, v10
    v_fmac_f32 v25, v122, v11
    v_fmac_f32 v26, v122, v14
    v_fmac_f32 v27, v122, v15
    s_waitcnt vmcnt(4)
    v_lshlrev_b32 v4, 16, v44
    v_and_b32 v5, 0xffff0000, v44
    v_lshlrev_b32 v8, 16, v45
    v_and_b32 v9, 0xffff0000, v45
    v_lshlrev_b32 v10, 16, v46
    v_and_b32 v11, 0xffff0000, v46
    v_lshlrev_b32 v14, 16, v47
    v_and_b32 v15, 0xffff0000, v47
    v_fmac_f32 v20, v123, v4
    v_fmac_f32 v21, v123, v5
    v_fmac_f32 v22, v123, v8
    v_fmac_f32 v23, v123, v9
    v_fmac_f32 v24, v123, v10
    v_fmac_f32 v25, v123, v11
    v_fmac_f32 v26, v123, v14
    v_fmac_f32 v27, v123, v15
    s_waitcnt vmcnt(3)
    v_lshlrev_b32 v4, 16, v48
    v_and_b32 v5, 0xffff0000, v48
    v_lshlrev_b32 v8, 16, v49
    v_and_b32 v9, 0xffff0000, v49
    v_lshlrev_b32 v10, 16, v50
    v_and_b32 v11, 0xffff0000, v50
    v_lshlrev_b32 v14, 16, v51
    v_and_b32 v15, 0xffff0000, v51
    v_fmac_f32 v20, v124, v4
    v_fmac_f32 v21, v124, v5
    v_fmac_f32 v22, v124, v8
    v_fmac_f32 v23, v124, v9
    v_fmac_f32 v24, v124, v10
    v_fmac_f32 v25, v124, v11
    v_fmac_f32 v26, v124, v14
    v_fmac_f32 v27, v124, v15
    s_waitcnt vmcnt(2)
    v_lshlrev_b32 v4, 16, v52
    v_and_b32 v5, 0xffff0000, v52
    v_lshlrev_b32 v8, 16, v53
    v_and_b32 v9, 0xffff0000, v53
    v_lshlrev_b32 v10, 16, v54
    v_and_b32 v11, 0xffff0000, v54
    v_lshlrev_b32 v14, 16, v55
    v_and_b32 v15, 0xffff0000, v55
    v_fmac_f32 v20, v125, v4
    v_fmac_f32 v21, v125, v5
    v_fmac_f32 v22, v125, v8
    v_fmac_f32 v23, v125, v9
    v_fmac_f32 v24, v125, v10
    v_fmac_f32 v25, v125, v11
    v_fmac_f32 v26, v125, v14
    v_fmac_f32 v27, v125, v15
    s_waitcnt vmcnt(1)
    v_lshlrev_b32 v4, 16, v56
    v_and_b32 v5, 0xffff0000, v56
    v_lshlrev_b32 v8, 16, v57
    v_and_b32 v9, 0xffff0000, v57
    v_lshlrev_b32 v10, 16, v58
    v_and_b32 v11, 0xffff0000, v58
    v_lshlrev_b32 v14, 16, v59
    v_and_b32 v15, 0xffff0000, v59
    v_fmac_f32 v20, v126, v4
    v_fmac_f32 v21, v126, v5
    v_fmac_f32 v22, v126, v8
    v_fmac_f32 v23, v126, v9
    v_fmac_f32 v24, v126, v10
    v_fmac_f32 v25, v126, v11
    v_fmac_f32 v26, v126, v14
    v_fmac_f32 v27, v126, v15
    s_waitcnt vmcnt(0)
    v_lshlrev_b32 v4, 16, v60
    v_and_b32 v5, 0xffff0000, v60
    v_lshlrev_b32 v8, 16, v61
    v_and_b32 v9, 0xffff0000, v61
    v_lshlrev_b32 v10, 16, v62
    v_and_b32 v11, 0xffff0000, v62
    v_lshlrev_b32 v14, 16, v63
    v_and_b32 v15, 0xffff0000, v63
    v_fmac_f32 v20, v127, v4
    v_fmac_f32 v21, v127, v5
    v_fmac_f32 v22, v127, v8
    v_fmac_f32 v23, v127, v9
    v_fmac_f32 v24, v127, v10
    v_fmac_f32 v25, v127, v11
    v_fmac_f32 v26, v127, v14
    v_fmac_f32 v27, v127, v15
    v_lshrrev_b32 v4, 4, v1
    s_lshl_b32 s7, s6, 2
    v_add_u32 v4, s7, v4
    v_lshlrev_b32 v4, 2, v4
    v_add_u32 v4, 47104, v4
    ds_write_b32 v4, v28
    s_waitcnt lgkmcnt(0)
    s_barrier
    v_lshlrev_b32 v5, 2, v1
    ds_read_b32 v6, v5 offset:47104
    v_lshrrev_b32 v8, 4, v1
    s_lshl_b32 s7, s6, 2
    v_add_u32 v8, s7, v8
    s_movk_i32 s7, 544
    v_mul_lo_u32 v8, v8, s7
    v_and_b32 v9, 15, v1
    v_lshl_add_u32 v8, v9, 5, v8
    s_waitcnt lgkmcnt(0)
    s_nop 1
    v_max_f32_dpp v6, v6, v6 row_ror:8 row_mask:0xf bank_mask:0xf
    s_nop 1
    v_max_f32_dpp v6, v6, v6 row_ror:4 row_mask:0xf bank_mask:0xf
    s_nop 1
    v_max_f32_dpp v6, v6, v6 row_ror:2 row_mask:0xf bank_mask:0xf
    s_nop 1
    v_max_f32_dpp v6, v6, v6 row_ror:1 row_mask:0xf bank_mask:0xf
    v_mov_b32 v9, v6
    s_nop 1
    v_permlane16_swap_b32 v6, v9
    s_nop 1
    v_max_f32 v6, v6, v9
    v_mov_b32 v9, v6
    s_nop 1
    v_permlane32_swap_b32 v6, v9
    s_nop 1
    v_max_f32 v6, v6, v9
    v_sub_f32 v6, v28, v6
    v_mul_f32 v6, 0x3fb8aa3b, v6
    v_exp_f32 v6, v6
    s_nop 0
    v_mul_f32 v20, v20, v6
    v_mul_f32 v21, v21, v6
    v_mul_f32 v22, v22, v6
    v_mul_f32 v23, v23, v6
    v_mul_f32 v24, v24, v6
    v_mul_f32 v25, v25, v6
    v_mul_f32 v26, v26, v6
    v_mul_f32 v27, v27, v6
    v_mul_f32 v30, v30, v6
    ds_write_b128 v8, v[20:23] offset:2048
    ds_write_b128 v8, v[24:27] offset:2064
    ds_write_b32 v4, v30 offset:256
    v_lshrrev_b32 v9, 3, v1
    s_movk_i32 s7, 544
    v_mul_lo_u32 v9, v9, s7
    v_and_b32 v10, 7, v1
    s_lshl_b32 s7, s6, 5
    v_lshl_add_u32 v9, v10, 2, v9
    v_add_u32 v9, s7, v9
    v_and_b32 v10, 15, v1
    v_lshrrev_b32 v11, 4, v1
    v_and_b32 v12, 1, v11
    v_lshl_add_u32 v12, v10, 1, v12
    v_lshlrev_b32 v12, 8, v12
    v_lshrrev_b32 v11, 1, v11
    s_mul_i32 s8, s6, 3
    v_add_u32 v11, s8, v11
    v_lshl_add_u32 v12, v11, 2, v12
    v_add_u32 v12, 36864, v12
    v_lshlrev_b32 v11, 2, v11
    v_sub_u32 v13, v12, v11
    s_add_u32 s7, s8, 2
    s_lshl_b32 s7, s7, 2
    v_add_u32 v13, s7, v13
    s_waitcnt lgkmcnt(0)
    s_barrier
    ds_read_b32 v32, v9 offset:2048
    ds_read_b32 v33, v9 offset:6400
    ds_read_b32 v34, v9 offset:10752
    ds_read_b32 v35, v9 offset:15104
    ds_read_b32 v36, v9 offset:19456
    ds_read_b32 v37, v9 offset:23808
    ds_read_b32 v38, v9 offset:28160
    ds_read_b32 v39, v9 offset:32512
    ds_read_b32 v6, v5 offset:47360
    ds_read_b32 v40, v12
    ds_read_b32 v41, v13
    s_waitcnt lgkmcnt(0)
    v_add_f32 v32, v32, v33
    v_add_f32 v34, v34, v35
    v_add_f32 v36, v36, v37
    v_add_f32 v38, v38, v39
    v_add_f32 v32, v32, v34
    v_add_f32 v36, v36, v38
    v_add_f32 v32, v32, v36
    s_nop 1
    v_add_f32_dpp v32, v32, v32 row_ror:8 row_mask:0xf bank_mask:0xf
    v_add_f32_dpp v6, v6, v6 row_ror:8 row_mask:0xf bank_mask:0xf
    v_add_f32_dpp v40, v40, v40 row_ror:8 row_mask:0xf bank_mask:0xf
    v_add_f32_dpp v41, v41, v41 row_ror:8 row_mask:0xf bank_mask:0xf
    s_nop 0
    v_add_f32_dpp v6, v6, v6 row_ror:4 row_mask:0xf bank_mask:0xf
    v_add_f32_dpp v40, v40, v40 row_ror:4 row_mask:0xf bank_mask:0xf
    v_add_f32_dpp v41, v41, v41 row_ror:4 row_mask:0xf bank_mask:0xf
    s_nop 0
    v_add_f32_dpp v6, v6, v6 row_ror:2 row_mask:0xf bank_mask:0xf
    v_add_f32_dpp v40, v40, v40 row_ror:2 row_mask:0xf bank_mask:0xf
    v_add_f32_dpp v41, v41, v41 row_ror:2 row_mask:0xf bank_mask:0xf
    s_nop 0
    v_add_f32_dpp v6, v6, v6 row_ror:1 row_mask:0xf bank_mask:0xf
    v_add_f32_dpp v40, v40, v40 row_ror:1 row_mask:0xf bank_mask:0xf
    v_add_f32_dpp v41, v41, v41 row_ror:1 row_mask:0xf bank_mask:0xf
    v_mov_b32 v33, v32
    v_mov_b32 v34, v6
    s_nop 1
    v_permlane16_swap_b32 v32, v33
    v_permlane16_swap_b32 v6, v34
    s_nop 1
    v_add_f32 v32, v32, v33
    v_add_f32 v6, v6, v34
    v_mov_b32 v33, v32
    v_mov_b32 v34, v6
    s_nop 1
    v_permlane32_swap_b32 v32, v33
    v_permlane32_swap_b32 v6, v34
    s_nop 1
    v_add_f32 v32, v32, v33
    v_add_f32 v6, v6, v34
    v_rcp_f32 v6, v6
    v_cvt_pk_bf16_f32 v40, v40, v40
    v_lshlrev_b32 v40, 16, v40
    v_cvt_pk_bf16_f32 v41, v41, v41
    v_lshlrev_b32 v41, 16, v41
    v_mul_f32 v32, v32, v6
    v_cvt_pk_bf16_f32 v32, v32, v32
    v_lshlrev_b32 v32, 16, v32
    s_nop 1
    v_readlane_b32 s16, v32, 0
    v_readlane_b32 s17, v32, 1
    v_readlane_b32 s18, v32, 2
    v_readlane_b32 s19, v32, 3
    v_readlane_b32 s20, v32, 4
    v_readlane_b32 s21, v32, 5
    v_readlane_b32 s22, v32, 6
    v_readlane_b32 s23, v32, 7
    v_readlane_b32 s32, v40, 0
    v_readlane_b32 s33, v40, 16
    v_readlane_b32 s34, v40, 32
    v_readlane_b32 s35, v40, 48
    v_readlane_b32 s36, v41, 0
    v_readlane_b32 s37, v41, 16
    s_nop 1
    s_lshr_b32 s24, s16, 16
    s_lshr_b32 s25, s17, 16
    s_lshr_b32 s26, s18, 16
    s_lshr_b32 s27, s19, 16
    s_lshr_b32 s28, s20, 16
    s_lshr_b32 s29, s21, 16
    s_lshr_b32 s30, s22, 16
    s_lshr_b32 s31, s23, 16
    s_lshl_b32 s9, s91, 3
    v_max_f32 v28, s32, 0
    v_mul_f32 v28, s33, v28
    v_cvt_pk_bf16_f32 v28, v28, v28
    v_lshlrev_b32 v28, 16, v28
    s_add_u32 s10, s8, 0
    s_cmp_lt_u32 s10, s9
    s_cselect_b32 s10, -1, 0
    v_and_b32 v28, s10, v28
    v_lshrrev_b32 v8, 16, v28
    v_max_f32 v29, s34, 0
    v_mul_f32 v29, s35, v29
    v_cvt_pk_bf16_f32 v29, v29, v29
    v_lshlrev_b32 v29, 16, v29
    s_add_u32 s10, s8, 1
    s_cmp_lt_u32 s10, s9
    s_cselect_b32 s10, -1, 0
    v_and_b32 v29, s10, v29
    v_lshrrev_b32 v9, 16, v29
    v_max_f32 v30, s36, 0
    v_mul_f32 v30, s37, v30
    v_cvt_pk_bf16_f32 v30, v30, v30
    v_lshlrev_b32 v30, 16, v30
    s_add_u32 s10, s8, 2
    s_cmp_lt_u32 s10, s9
    s_cselect_b32 s10, -1, 0
    v_and_b32 v30, s10, v30
    v_lshrrev_b32 v10, 16, v30
    s_waitcnt vmcnt(0)
    v_dot2_f32_bf16 v20, v64, s24, 0
    v_dot2_f32_bf16 v21, v64, s16, 0
    v_dot2_f32_bf16 v22, v65, s24, 0
    v_dot2_f32_bf16 v23, v65, s16, 0
    v_dot2_f32_bf16 v24, v66, s24, 0
    v_dot2_f32_bf16 v25, v66, s16, 0
    v_dot2_f32_bf16 v26, v67, s24, 0
    v_dot2_f32_bf16 v27, v67, s16, 0
    v_dot2_f32_bf16 v20, v68, s25, v20
    v_dot2_f32_bf16 v21, v68, s17, v21
    v_dot2_f32_bf16 v22, v69, s25, v22
    v_dot2_f32_bf16 v23, v69, s17, v23
    v_dot2_f32_bf16 v24, v70, s25, v24
    v_dot2_f32_bf16 v25, v70, s17, v25
    v_dot2_f32_bf16 v26, v71, s25, v26
    v_dot2_f32_bf16 v27, v71, s17, v27
    v_dot2_f32_bf16 v20, v72, s26, v20
    v_dot2_f32_bf16 v21, v72, s18, v21
    v_dot2_f32_bf16 v22, v73, s26, v22
    v_dot2_f32_bf16 v23, v73, s18, v23
    v_dot2_f32_bf16 v24, v74, s26, v24
    v_dot2_f32_bf16 v25, v74, s18, v25
    v_dot2_f32_bf16 v26, v75, s26, v26
    v_dot2_f32_bf16 v27, v75, s18, v27
    v_dot2_f32_bf16 v20, v76, s27, v20
    v_dot2_f32_bf16 v21, v76, s19, v21
    v_dot2_f32_bf16 v22, v77, s27, v22
    v_dot2_f32_bf16 v23, v77, s19, v23
    v_dot2_f32_bf16 v24, v78, s27, v24
    v_dot2_f32_bf16 v25, v78, s19, v25
    v_dot2_f32_bf16 v26, v79, s27, v26
    v_dot2_f32_bf16 v27, v79, s19, v27
    v_dot2_f32_bf16 v20, v80, s28, v20
    v_dot2_f32_bf16 v21, v80, s20, v21
    v_dot2_f32_bf16 v22, v81, s28, v22
    v_dot2_f32_bf16 v23, v81, s20, v23
    v_dot2_f32_bf16 v24, v82, s28, v24
    v_dot2_f32_bf16 v25, v82, s20, v25
    v_dot2_f32_bf16 v26, v83, s28, v26
    v_dot2_f32_bf16 v27, v83, s20, v27
    v_dot2_f32_bf16 v20, v84, s29, v20
    v_dot2_f32_bf16 v21, v84, s21, v21
    v_dot2_f32_bf16 v22, v85, s29, v22
    v_dot2_f32_bf16 v23, v85, s21, v23
    v_dot2_f32_bf16 v24, v86, s29, v24
    v_dot2_f32_bf16 v25, v86, s21, v25
    v_dot2_f32_bf16 v26, v87, s29, v26
    v_dot2_f32_bf16 v27, v87, s21, v27
    v_dot2_f32_bf16 v20, v88, s30, v20
    v_dot2_f32_bf16 v21, v88, s22, v21
    v_dot2_f32_bf16 v22, v89, s30, v22
    v_dot2_f32_bf16 v23, v89, s22, v23
    v_dot2_f32_bf16 v24, v90, s30, v24
    v_dot2_f32_bf16 v25, v90, s22, v25
    v_dot2_f32_bf16 v26, v91, s30, v26
    v_dot2_f32_bf16 v27, v91, s22, v27
    v_dot2_f32_bf16 v20, v92, s31, v20
    v_dot2_f32_bf16 v21, v92, s23, v21
    v_dot2_f32_bf16 v22, v93, s31, v22
    v_dot2_f32_bf16 v23, v93, s23, v23
    v_dot2_f32_bf16 v24, v94, s31, v24
    v_dot2_f32_bf16 v25, v94, s23, v25
    v_dot2_f32_bf16 v26, v95, s31, v26
    v_dot2_f32_bf16 v27, v95, s23, v27
    v_dot2_f32_bf16 v20, v96, v8, v20
    v_dot2_f32_bf16 v21, v96, v28, v21
    v_dot2_f32_bf16 v22, v97, v8, v22
    v_dot2_f32_bf16 v23, v97, v28, v23
    v_dot2_f32_bf16 v24, v98, v8, v24
    v_dot2_f32_bf16 v25, v98, v28, v25
    v_dot2_f32_bf16 v26, v99, v8, v26
    v_dot2_f32_bf16 v27, v99, v28, v27
    v_dot2_f32_bf16 v20, v100, v9, v20
    v_dot2_f32_bf16 v21, v100, v29, v21
    v_dot2_f32_bf16 v22, v101, v9, v22
    v_dot2_f32_bf16 v23, v101, v29, v23
    v_dot2_f32_bf16 v24, v102, v9, v24
    v_dot2_f32_bf16 v25, v102, v29, v25
    v_dot2_f32_bf16 v26, v103, v9, v26
    v_dot2_f32_bf16 v27, v103, v29, v27
    v_dot2_f32_bf16 v20, v104, v10, v20
    v_dot2_f32_bf16 v21, v104, v30, v21
    v_dot2_f32_bf16 v22, v105, v10, v22
    v_dot2_f32_bf16 v23, v105, v30, v23
    v_dot2_f32_bf16 v24, v106, v10, v24
    v_dot2_f32_bf16 v25, v106, v30, v25
    v_dot2_f32_bf16 v26, v107, v10, v26
    v_dot2_f32_bf16 v27, v107, v30, v27
    s_lshl_b32 s7, s6, 11
    s_add_u32 s7, s7, 47872
    v_lshlrev_b32 v4, 5, v1
    v_add_u32 v4, s7, v4
    ds_write_b128 v4, v[20:23]
    ds_write_b128 v4, v[24:27] offset:16
    s_waitcnt lgkmcnt(0)
    s_barrier
    s_cmp_ge_u32 s6, 8
    s_cbranch_scc1 L_pub_done
    v_lshlrev_b32 v4, 2, v0
    v_add_u32 v5, 47872, v4
    ds_read_b32 v80, v5 offset:0
    ds_read_b32 v81, v5 offset:2048
    ds_read_b32 v82, v5 offset:4096
    ds_read_b32 v83, v5 offset:6144
    ds_read_b32 v84, v5 offset:8192
    ds_read_b32 v85, v5 offset:10240
    ds_read_b32 v86, v5 offset:12288
    ds_read_b32 v87, v5 offset:14336
    ds_read_b32 v88, v5 offset:16384
    ds_read_b32 v89, v5 offset:18432
    ds_read_b32 v90, v5 offset:20480
    ds_read_b32 v91, v5 offset:22528
    ds_read_b32 v92, v5 offset:24576
    ds_read_b32 v93, v5 offset:26624
    ds_read_b32 v94, v5 offset:28672
    ds_read_b32 v95, v5 offset:30720
    s_waitcnt lgkmcnt(0)
    v_add_f32 v80, v80, v81
    v_add_f32 v80, v80, v82
    v_add_f32 v80, v80, v83
    v_add_f32 v80, v80, v84
    v_add_f32 v80, v80, v85
    v_add_f32 v80, v80, v86
    v_add_f32 v80, v80, v87
    v_add_f32 v80, v80, v88
    v_add_f32 v80, v80, v89
    v_add_f32 v80, v80, v90
    v_add_f32 v80, v80, v91
    v_add_f32 v80, v80, v92
    v_add_f32 v80, v80, v93
    v_add_f32 v80, v80, v94
    v_add_f32 v80, v80, v95
    s_lshl_b32 s7, s2, 11
    buffer_store_dword v80, v4, s[80:83], s7 offen sc1
    s_waitcnt vmcnt(0)
L_pub_done:
    s_barrier
    s_cmp_lg_u32 s6, 0
    s_cbranch_scc1 L_atom_done
    s_lshl_b32 s7, s4, 2
    v_mov_b32 v4, s7
    v_mov_b32 v5, 1
    v_cmp_eq_u32 vcc, 0, v0
    s_and_saveexec_b64 s[10:11], vcc
    buffer_atomic_add v5, v4, s[76:79], 0 offen sc0 sc1
    s_waitcnt vmcnt(0)
    v_mov_b32 v6, 47616
    ds_write_b32 v6, v5
    s_mov_b64 exec, s[10:11]
    s_waitcnt lgkmcnt(0)
L_atom_done:
    s_barrier
    v_mov_b32 v6, 47616
    ds_read_b32 v5, v6
    s_waitcnt lgkmcnt(0)
    v_readfirstlane_b32 s7, v5
    s_nop 3
    s_cmp_lg_u32 s7, 31
    s_cbranch_scc1 L_end
    s_cmp_ge_u32 s6, 8
    s_cbranch_scc1 L_end
    v_lshlrev_b32 v4, 2, v0
    s_lshl_b32 s7, s4, 16
    s_add_u32 s8, s7, 0
    buffer_load_dword v64, v4, s[80:83], s8 offen sc1
    s_add_u32 s8, s7, 2048
    buffer_load_dword v65, v4, s[80:83], s8 offen sc1
    s_add_u32 s8, s7, 4096
    buffer_load_dword v66, v4, s[80:83], s8 offen sc1
    s_add_u32 s8, s7, 6144
    buffer_load_dword v67, v4, s[80:83], s8 offen sc1
    s_add_u32 s8, s7, 8192
    buffer_load_dword v68, v4, s[80:83], s8 offen sc1
    s_add_u32 s8, s7, 10240
    buffer_load_dword v69, v4, s[80:83], s8 offen sc1
    s_add_u32 s8, s7, 12288
    buffer_load_dword v70, v4, s[80:83], s8 offen sc1
    s_add_u32 s8, s7, 14336
    buffer_load_dword v71, v4, s[80:83], s8 offen sc1
    s_add_u32 s8, s7, 16384
    buffer_load_dword v72, v4, s[80:83], s8 offen sc1
    s_add_u32 s8, s7, 18432
    buffer_load_dword v73, v4, s[80:83], s8 offen sc1
    s_add_u32 s8, s7, 20480
    buffer_load_dword v74, v4, s[80:83], s8 offen sc1
    s_add_u32 s8, s7, 22528
    buffer_load_dword v75, v4, s[80:83], s8 offen sc1
    s_add_u32 s8, s7, 24576
    buffer_load_dword v76, v4, s[80:83], s8 offen sc1
    s_add_u32 s8, s7, 26624
    buffer_load_dword v77, v4, s[80:83], s8 offen sc1
    s_add_u32 s8, s7, 28672
    buffer_load_dword v78, v4, s[80:83], s8 offen sc1
    s_add_u32 s8, s7, 30720
    buffer_load_dword v79, v4, s[80:83], s8 offen sc1
    s_add_u32 s8, s7, 32768
    buffer_load_dword v80, v4, s[80:83], s8 offen sc1
    s_add_u32 s8, s7, 34816
    buffer_load_dword v81, v4, s[80:83], s8 offen sc1
    s_add_u32 s8, s7, 36864
    buffer_load_dword v82, v4, s[80:83], s8 offen sc1
    s_add_u32 s8, s7, 38912
    buffer_load_dword v83, v4, s[80:83], s8 offen sc1
    s_add_u32 s8, s7, 40960
    buffer_load_dword v84, v4, s[80:83], s8 offen sc1
    s_add_u32 s8, s7, 43008
    buffer_load_dword v85, v4, s[80:83], s8 offen sc1
    s_add_u32 s8, s7, 45056
    buffer_load_dword v86, v4, s[80:83], s8 offen sc1
    s_add_u32 s8, s7, 47104
    buffer_load_dword v87, v4, s[80:83], s8 offen sc1
    s_add_u32 s8, s7, 49152
    buffer_load_dword v88, v4, s[80:83], s8 offen sc1
    s_add_u32 s8, s7, 51200
    buffer_load_dword v89, v4, s[80:83], s8 offen sc1
    s_add_u32 s8, s7, 53248
    buffer_load_dword v90, v4, s[80:83], s8 offen sc1
    s_add_u32 s8, s7, 55296
    buffer_load_dword v91, v4, s[80:83], s8 offen sc1
    s_add_u32 s8, s7, 57344
    buffer_load_dword v92, v4, s[80:83], s8 offen sc1
    s_add_u32 s8, s7, 59392
    buffer_load_dword v93, v4, s[80:83], s8 offen sc1
    s_add_u32 s8, s7, 61440
    buffer_load_dword v94, v4, s[80:83], s8 offen sc1
    s_add_u32 s8, s7, 63488
    buffer_load_dword v95, v4, s[80:83], s8 offen sc1
    v_lshlrev_b32 v5, 1, v0
    buffer_load_ushort v6, v5, s[68:71], 0 offen
    s_waitcnt vmcnt(0)
    v_add_f32 v64, v64, v65
    v_add_f32 v64, v64, v66
    v_add_f32 v64, v64, v67
    v_add_f32 v64, v64, v68
    v_add_f32 v64, v64, v69
    v_add_f32 v64, v64, v70
    v_add_f32 v64, v64, v71
    v_add_f32 v64, v64, v72
    v_add_f32 v64, v64, v73
    v_add_f32 v64, v64, v74
    v_add_f32 v64, v64, v75
    v_add_f32 v64, v64, v76
    v_add_f32 v64, v64, v77
    v_add_f32 v64, v64, v78
    v_add_f32 v64, v64, v79
    v_add_f32 v64, v64, v80
    v_add_f32 v64, v64, v81
    v_add_f32 v64, v64, v82
    v_add_f32 v64, v64, v83
    v_add_f32 v64, v64, v84
    v_add_f32 v64, v64, v85
    v_add_f32 v64, v64, v86
    v_add_f32 v64, v64, v87
    v_add_f32 v64, v64, v88
    v_add_f32 v64, v64, v89
    v_add_f32 v64, v64, v90
    v_add_f32 v64, v64, v91
    v_add_f32 v64, v64, v92
    v_add_f32 v64, v64, v93
    v_add_f32 v64, v64, v94
    v_add_f32 v64, v64, v95
    v_lshlrev_b32 v6, 16, v6
    v_add_f32 v64, v64, v6
    v_cvt_pk_bf16_f32 v64, v64, v64
    buffer_store_short v64, v5, s[72:75], 0 offen
L_end:
    s_endpgm
.section .rodata,"a"
.p2align 6
.amdhsa_kernel parallel_sum__gqa_block_cached__glu_gated_reglu__decode_kernel
  .amdhsa_next_free_vgpr 128
  .amdhsa_next_free_sgpr 102
  .amdhsa_accum_offset 128
  .amdhsa_group_segment_fixed_size 0
  .amdhsa_kernarg_size 96
  .amdhsa_user_sgpr_count 2
  .amdhsa_user_sgpr_kernarg_segment_ptr 1
  .amdhsa_system_sgpr_workgroup_id_x 1
.end_amdhsa_kernel
```
